```python
import torch

def _softmax(x, axis=-1):
    return torch.softmax(x, dim=axis)
def _gelu(x):
    return torch.nn.functional.gelu(x, approximate="tanh")
def _silu(x):
    return torch.nn.functional.silu(x)
def _sigmoid(x):
    return torch.sigmoid(x)
def _layernorm(x, axis=-1, eps=1e-5):
    m = x.mean(dim=axis, keepdim=True)
    v = x.var(dim=axis, keepdim=True, unbiased=False)
    return (x - m) / torch.sqrt(v + eps)
def _scatter_add(tgt, idx, src, axis=0):
    return tgt.clone().index_add_(axis, idx, src)
def _segment_sum(src, seg, n):
    out = torch.zeros((n,) + src.shape[1:], dtype=src.dtype)
    return out.index_add_(0, seg, src)
def _pad(x, pw):
    flat = tuple(v for pair in reversed(pw) for v in pair)
    return torch.nn.functional.pad(x, flat)

kernel_name = 'recurrent_scan__spectral_fnet__geglu_ffn__prompt'

def setup_inputs():

    _w = (lambda a: (lambda t: t.to(torch.bfloat16) if t.is_floating_point() else t)(torch.as_tensor(a)))
    def _A_setup():
        B, S, D = 1, 2048, 512
        ns = torch.arange(S)[:, None] * torch.arange(S)[None, :]
        nd = torch.arange(D)[:, None] * torch.arange(D)[None, :]
        Ws_re = torch.cos(-2.0 * torch.pi * ns / S).to(float)
        Ws_im = torch.sin(-2.0 * torch.pi * ns / S).to(float)
        Wd_re = torch.cos(-2.0 * torch.pi * nd / D).to(float)
        Wd_im = torch.sin(-2.0 * torch.pi * nd / D).to(float)
        return {
            "x": _w((lambda *s: torch.randn(*s, dtype=torch.bfloat16) * 0.05)(B, S, D)),
            "dft_seq_re": _w(Ws_re),
            "dft_seq_im": _w(Ws_im),
            "dft_hid_re": _w(Wd_re),
            "dft_hid_im": _w(Wd_im),
        }
    _A_in = _A_setup()

    def _B_setup():
        B, S, D, F = 1, 2048, 512, 1376
        return {
            "x": _w((lambda *s: torch.randn(*s, dtype=torch.bfloat16) * 0.05)(B, S, D)),
            "w_gate": _w((lambda *s: torch.randn(*s, dtype=torch.bfloat16) * 0.05)(D, F)),
            "w_up": _w((lambda *s: torch.randn(*s, dtype=torch.bfloat16) * 0.05)(D, F)),
            "w_down": _w((lambda *s: torch.randn(*s, dtype=torch.bfloat16) * 0.05)(F, D)),
        }
    _B_in = _B_setup()

    return {
        "A_x": _A_in["x"],
        "A_dft_seq_re": _A_in["dft_seq_re"],
        "A_dft_seq_im": _A_in["dft_seq_im"],
        "A_dft_hid_re": _A_in["dft_hid_re"],
        "A_dft_hid_im": _A_in["dft_hid_im"],
        "B_x": _B_in["x"],
        "B_w_gate": _B_in["w_gate"],
        "B_w_up": _B_in["w_up"],
        "B_w_down": _B_in["w_down"],
    }

def reference(A_x, A_dft_seq_re, A_dft_seq_im, A_dft_hid_re, A_dft_hid_im, B_x, B_w_gate, B_w_up, B_w_down):
    def _A_ref(x, dft_seq_re, dft_seq_im, dft_hid_re, dft_hid_im):
        a = torch.einsum("bsd,ed->bse", x, dft_hid_re)
        b = torch.einsum("bsd,ed->bse", x, dft_hid_im)
        y = torch.einsum("ts,bse->bte", dft_seq_re, a) - torch.einsum("ts,bse->bte", dft_seq_im, b)
        return y

    def _B_ref(x, w_gate, w_up, w_down):
        return (_gelu(x @ w_gate) * (x @ w_up)) @ w_down

    x = A_x
    xn = _layernorm(x, axis=-1)
    s = _A_ref(xn, A_dft_seq_re, A_dft_seq_im, A_dft_hid_re, A_dft_hid_im)
    g = _silu(_B_ref(xn, B_w_gate, B_w_up, B_w_down))
    return x + s * g
```

```asm
; @launch grid=(256,1,1) block=(512,1,1) lds=163840
.amdgcn_target "amdgcn-amd-amdhsa--gfx950"
.text
.globl recurrent_scan__spectral_fnet__geglu_ffn__prompt_kernel
.p2align 8
.type recurrent_scan__spectral_fnet__geglu_ffn__prompt_kernel,@function
recurrent_scan__spectral_fnet__geglu_ffn__prompt_kernel:
    s_cmp_ge_u32 s2, 256
    s_cbranch_scc1 L_END
    s_load_dwordx2 s[4:5], s[0:1], 0
    s_load_dwordx4 s[8:11], s[0:1], 24
    s_load_dwordx4 s[12:15], s[0:1], 48
    s_load_dwordx2 s[18:19], s[0:1], 64
    s_load_dwordx2 s[82:83], s[0:1], 72
    s_load_dwordx2 s[80:81], s[0:1], 80
    s_load_dwordx2 s[16:17], s[0:1], 88
    v_lshrrev_b32 v1, 6, v0
    v_and_b32 v0, 63, v0
    s_and_b32 s3, s2, 7
    v_readfirstlane_b32 s20, v1
    s_lshr_b32 s6, s2, 3
    s_lshl_b32 s36, s3, 1
    s_cmp_ge_u32 s6, 11
    s_cselect_b32 s37, 1, 0
    s_add_u32 s22, s36, s37
    s_mul_i32 s37, s37, 11
    s_sub_u32 s23, s6, s37
    s_mov_b32 s21, 0
    s_cmp_lt_u32 s6, 22
    s_cbranch_scc1 L_ROLED
    s_sub_u32 s6, s6, 22
    s_lshr_b32 s37, s6, 2
    s_add_u32 s22, s36, s37
    s_and_b32 s23, s6, 3
    s_mov_b32 s21, 1
    s_cmp_lt_u32 s6, 8
    s_cbranch_scc1 L_ROLED
    s_sub_u32 s6, s6, 8
    s_add_u32 s23, s36, s6
    s_mov_b32 s21, 2
    s_cmp_lt_u32 s23, 11
    s_cbranch_scc1 L_CS
L_ROLED:
    s_mul_i32 s3, s22, 11
    s_lshl_b32 s37, s22, 2
    s_add_u32 s37, s37, 176
    s_cmp_eq_u32 s21, 0
    s_cselect_b32 s3, s3, s37
    s_add_u32 s3, s3, s23
    s_cmp_lt_u32 s20, 4
    s_cbranch_scc1 L_MMA
    s_sub_u32 s36, s20, 4
    s_cmp_eq_u32 s21, 2
    s_cbranch_scc1 L_HI
    v_lshrrev_b32 v2, 3, v0
    v_lshrrev_b32 v3, 4, v0
    v_and_b32 v4, 7, v0
    v_xor_b32 v4, v4, v3
    v_xor_b32 v5, 4, v4
    v_lshlrev_b32 v4, 4, v4
    v_lshlrev_b32 v5, 4, v5
    s_lshr_b32 s37, s36, 1
    s_and_b32 s38, s36, 1
    s_lshl_b32 s38, s38, 5
    s_add_u32 s37, s37, s38
    s_lshl_b32 s38, s22, 1
    s_add_u32 s37, s37, s38
    s_lshl_b32 s37, s37, 10
    v_lshlrev_b32 v6, 16, v2
    v_add_u32 v6, s37, v6
    v_add_u32 v16, v6, v4
    v_add_u32 v17, v6, v5
    v_add_u32 v17, 0x80000, v17
    v_add_u32 v18, 0x100000, v16
    v_add_u32 v19, 0x100000, v17
    s_lshl_b32 s49, s36, 12
    s_cmp_eq_u32 s21, 0
    s_cbranch_scc0 L_HD
    v_bfe_u32 v4, v0, 1, 3
    v_lshlrev_b32 v5, 1, v3
    s_and_b32 s37, s36, 1
    s_lshr_b32 s38, s36, 1
    v_xor_b32 v4, v4, v5
    v_xor_b32 v4, s38, v4
    v_lshlrev_b32 v4, 5, v4
    v_and_b32 v5, 1, v0
    v_lshl_add_u32 v4, v5, 4, v4
    v_mul_u32_u24 v3, 2752, v3
    s_lshl_b32 s39, s23, 8
    v_add3_u32 v20, v3, v4, s39
    s_mul_i32 s50, s38, 22016
    s_lshl_b32 s51, s37, 14
    s_lshl_b32 s39, s38, 11
    s_add_u32 s51, s51, s39
    s_cmp_eq_u32 s37, 0
    s_waitcnt lgkmcnt(0)
    s_cselect_b32 s28, s12, s14
    s_cselect_b32 s29, s13, s15
    s_mov_b32 s30, 1409024
    s_mov_b32 s31, 0x00020000
    s_mov_b32 s24, s4
    s_mov_b32 s25, s5
    s_mov_b32 s26, 2097152
    s_mov_b32 s27, 0x00020000
    s_mov_b32 s59, 2130706432
    s_add_u32 m0, s49, 0
    s_movk_i32 s52, 0
    buffer_load_dwordx4 v16, s[24:27], s52 offen lds
    s_add_u32 m0, s51, 49152
    s_add_u32 s53, s50, 0
    buffer_load_dwordx4 v20, s[28:31], s53 offen lds
    s_add_u32 m0, s49, 1024
    s_movk_i32 s52, 0
    buffer_load_dwordx4 v17, s[24:27], s52 offen lds
    s_add_u32 m0, s51, 50176
    s_add_u32 s53, s50, 11008
    buffer_load_dwordx4 v20, s[28:31], s53 offen lds
    s_add_u32 m0, s49, 2048
    s_movk_i32 s52, 0
    buffer_load_dwordx4 v18, s[24:27], s52 offen lds
    s_add_u32 m0, s51, 53248
    s_add_u32 s53, s50, 44032
    buffer_load_dwordx4 v20, s[28:31], s53 offen lds
    s_add_u32 m0, s49, 3072
    s_movk_i32 s52, 0
    buffer_load_dwordx4 v19, s[24:27], s52 offen lds
    s_add_u32 m0, s51, 54272
    s_add_u32 s53, s50, 55040
    buffer_load_dwordx4 v20, s[28:31], s53 offen lds
    s_add_u32 m0, s51, 57344
    s_add_u32 s53, s50, 88064
    buffer_load_dwordx4 v20, s[28:31], s53 offen lds
    s_add_u32 m0, s51, 58368
    s_add_u32 s53, s50, 99072
    buffer_load_dwordx4 v20, s[28:31], s53 offen lds
    s_add_u32 m0, s51, 61440
    s_add_u32 s53, s50, 132096
    buffer_load_dwordx4 v20, s[28:31], s53 offen lds
    s_add_u32 m0, s51, 62464
    s_add_u32 s53, s50, 143104
    buffer_load_dwordx4 v20, s[28:31], s53 offen lds
    s_add_u32 m0, s49, 16384
    s_movk_i32 s52, 128
    buffer_load_dwordx4 v16, s[24:27], s52 offen lds
    s_add_u32 m0, s51, 81920
    s_add_u32 s53, s50, 176128
    buffer_load_dwordx4 v20, s[28:31], s53 offen lds
    s_mov_b32 s24, s4
    s_mov_b32 s25, s5
    s_mov_b32 s26, 2097152
    s_mov_b32 s27, 0x00020000
    s_mov_b32 s32, s16
    s_mov_b32 s33, s17
    s_mov_b32 s34, 10485760
    s_mov_b32 s35, 0x00020000
    s_mov_b32 s88, s80
    s_mov_b32 s89, s81
    s_mov_b32 s90, 256
    s_mov_b32 s91, 0x00020000
    s_add_u32 m0, s49, 17408
    s_movk_i32 s52, 128
    buffer_load_dwordx4 v17, s[24:27], s52 offen lds
    s_lshl_b32 s70, s36, 11
    s_lshl_b32 s71, s36, 12
    s_lshl_b32 s72, s36, 13
    s_mul_i32 s73, s36, 22
    s_and_b32 s53, s36, 1
    s_mul_i32 s97, s53, 2
    s_mul_i32 s98, s53, 6
    s_mul_i32 s99, s53, -17
    s_add_u32 s97, s97, s73
    s_add_u32 s98, s98, s73
    s_add_u32 s99, s99, s73
    s_lshl_b32 s94, s97, 14
    s_lshl_b32 s95, s98, 14
    s_lshl_b32 s96, s99, 14
    s_lshl_b32 s97, s97, 10
    s_lshl_b32 s98, s98, 10
    s_lshl_b32 s99, s99, 10
    s_and_b32 s74, s2, 7
    s_lshl_b32 s74, s74, 2
    s_lshr_b32 s75, s2, 6
    s_add_u32 s74, s74, s75
    s_bfe_u32 s75, s2, 0x30003
    s_mov_b32 s84, s18
    s_mov_b32 s85, s19
    s_mov_b32 s86, 1409024
    s_mov_b32 s87, 0x00020000
    v_lshrrev_b32 v6, 3, v0
    v_and_b32 v7, 7, v0
    v_lshlrev_b32 v6, 10, v6
    v_lshl_add_u32 v6, v7, 4, v6
    v_and_b32 v7, 16, v0
    v_lshlrev_b32 v7, 2, v7
    v_xor_b32 v6, v6, v7
    s_lshl_b32 s53, s75, 7
    v_add_u32 v4, s53, v6
    s_add_u32 m0, s51, 82944
    s_add_u32 s53, s50, 187136
    buffer_load_dwordx4 v20, s[28:31], s53 offen lds
    s_mul_i32 s53, s74, 176128
    v_lshlrev_b32 v6, 4, v0
    v_add_u32 v2, s53, v6
    v_add_u32 v3, 88064, v2
    v_lshrrev_b32 v7, 5, v0
    v_bfe_u32 v6, v0, 2, 2
    v_lshl_add_u32 v7, v7, 3, v6
    v_lshlrev_b32 v7, 7, v7
    v_lshrrev_b32 v6, 1, v6
    v_lshl_add_u32 v7, v6, 6, v7
    v_bfe_u32 v6, v0, 4, 1
    v_lshl_add_u32 v7, v6, 5, v7
    v_and_b32 v6, 3, v0
    v_lshl_add_u32 v7, v6, 3, v7
    v_add_u32 v8, s71, v7
    s_add_u32 s53, s72, 49152
    v_add_u32 v10, s53, v7
    v_add_u32 v12, 65536, v10
    s_add_u32 s53, s70, 147456
    v_add_u32 v14, s53, v7
    v_xor_b32 v9, 64, v8
    v_xor_b32 v11, 64, v10
    v_xor_b32 v13, 64, v12
    v_xor_b32 v15, 64, v14
    s_add_u32 m0, s49, 18432
    s_movk_i32 s52, 128
    buffer_load_dwordx4 v18, s[24:27], s52 offen lds
    v_mov_b32 v56, 162848
    v_mov_b32 v58, 0
    v_mov_b32 v59, 0
    v_mov_b32 v57, 1
    ds_write_b64 v56, v[58:59]
    s_add_u32 m0, s51, 86016
    s_add_u32 s53, s50, 220160
    buffer_load_dwordx4 v20, s[28:31], s53 offen lds
    s_add_u32 m0, s49, 19456
    s_movk_i32 s52, 128
    buffer_load_dwordx4 v19, s[24:27], s52 offen lds
    s_add_u32 m0, s51, 87040
    s_add_u32 s53, s50, 231168
    buffer_load_dwordx4 v20, s[28:31], s53 offen lds
    s_add_u32 m0, s51, 90112
    s_add_u32 s53, s50, 264192
    buffer_load_dwordx4 v20, s[28:31], s53 offen lds
    s_add_u32 m0, s51, 91136
    s_add_u32 s53, s50, 275200
    buffer_load_dwordx4 v20, s[28:31], s53 offen lds
    s_add_u32 m0, s51, 94208
    s_add_u32 s53, s50, 308224
    buffer_load_dwordx4 v20, s[28:31], s53 offen lds
    s_add_u32 m0, s51, 95232
    s_add_u32 s53, s50, 319232
    buffer_load_dwordx4 v20, s[28:31], s53 offen lds
    s_waitcnt vmcnt(12)
    s_waitcnt lgkmcnt(0)
    s_barrier
    s_add_u32 m0, s49, 32768
    s_movk_i32 s52, 256
    buffer_load_dwordx4 v16, s[24:27], s52 offen lds
    s_add_u32 m0, s51, 114688
    s_add_u32 s53, s50, 352256
    buffer_load_dwordx4 v20, s[28:31], s53 offen lds
    s_lshl_b32 s40, s3, 12
    s_add_u32 s40, s40, 704512
    v_min_u32 v52, 31, v0
    v_lshlrev_b32 v52, 7, v52
    s_cmp_lt_u32 s36, 2
    s_cbranch_scc0 L_HF_W2
    buffer_load_dword v53, v52, s[28:31], s40 offen
    s_branch L_HF_W9
L_HF_W2:
    s_lshl_b32 s40, s3, 1
    s_add_u32 s40, s40, s36
    s_sub_u32 s40, s40, 2
    s_mul_i32 s40, s40, 6
    v_min_u32 v52, 23, v0
    v_and_b32 v53, 3, v52
    v_lshrrev_b32 v52, 2, v52
    v_add_u32 v52, s40, v52
    v_min_u32 v52, 2047, v52
    v_lshlrev_b32 v53, 7, v53
    v_and_b32 v54, 31, v52
    v_lshl_add_u32 v53, v54, 16, v53
    v_bfe_u32 v54, v52, 5, 1
    v_lshl_add_u32 v53, v54, 15, v53
    v_lshrrev_b32 v54, 6, v52
    v_lshl_add_u32 v52, v54, 10, v53
    buffer_load_dword v53, v52, s[24:27], 0 offen offset:512
L_HF_W9:
    s_add_u32 m0, s49, 33792
    s_movk_i32 s52, 256
    buffer_load_dwordx4 v17, s[24:27], s52 offen lds
    v_mov_b32 v35, 0
    buffer_load_dwordx2 v[32:33], v35, s[88:91], 0 offen sc1
    s_add_u32 m0, s51, 115712
    s_add_u32 s53, s50, 363264
    buffer_load_dwordx4 v20, s[28:31], s53 offen lds
    s_add_u32 m0, s49, 34816
    s_movk_i32 s52, 256
    buffer_load_dwordx4 v18, s[24:27], s52 offen lds
    s_add_u32 m0, s51, 118784
    s_add_u32 s53, s50, 396288
    buffer_load_dwordx4 v20, s[28:31], s53 offen lds
    s_add_u32 m0, s49, 35840
    s_movk_i32 s52, 256
    buffer_load_dwordx4 v19, s[24:27], s52 offen lds
    s_add_u32 m0, s51, 119808
    s_add_u32 s53, s50, 407296
    buffer_load_dwordx4 v20, s[28:31], s53 offen lds
    s_add_u32 m0, s51, 122880
    s_add_u32 s53, s50, 440320
    buffer_load_dwordx4 v20, s[28:31], s53 offen lds
    s_add_u32 m0, s51, 123904
    s_add_u32 s53, s50, 451328
    buffer_load_dwordx4 v20, s[28:31], s53 offen lds
    s_add_u32 m0, s51, 126976
    s_add_u32 s53, s50, 484352
    buffer_load_dwordx4 v20, s[28:31], s53 offen lds
    s_add_u32 m0, s51, 128000
    s_add_u32 s53, s50, 495360
    buffer_load_dwordx4 v20, s[28:31], s53 offen lds
    s_waitcnt vmcnt(14)
    s_barrier
    s_add_u32 m0, s49, 0
    s_movk_i32 s52, 384
    buffer_load_dwordx4 v16, s[24:27], s52 offen lds
    s_add_u32 m0, s51, 49152
    s_add_u32 s53, s50, 528384
    buffer_load_dwordx4 v20, s[28:31], s53 offen lds
    s_lshl_b32 s40, s3, 2
    s_add_u32 s40, s40, s36
    s_mul_i32 s40, s40, 1536
    v_min_u32 v52, 11, v0
    v_lshlrev_b32 v52, 7, v52
    buffer_load_dword v54, v52, s[84:87], s40 offen
    s_add_u32 m0, s49, 1024
    s_movk_i32 s52, 384
    buffer_load_dwordx4 v17, s[24:27], s52 offen lds
    s_add_u32 m0, s51, 50176
    s_add_u32 s53, s50, 539392
    buffer_load_dwordx4 v20, s[28:31], s53 offen lds
    s_add_u32 m0, s49, 2048
    s_movk_i32 s52, 384
    buffer_load_dwordx4 v18, s[24:27], s52 offen lds
    s_add_u32 m0, s51, 53248
    s_add_u32 s53, s50, 572416
    buffer_load_dwordx4 v20, s[28:31], s53 offen lds
    s_add_u32 m0, s49, 3072
    s_movk_i32 s52, 384
    buffer_load_dwordx4 v19, s[24:27], s52 offen lds
    s_add_u32 m0, s51, 54272
    s_add_u32 s53, s50, 583424
    buffer_load_dwordx4 v20, s[28:31], s53 offen lds
    s_add_u32 m0, s51, 57344
    s_add_u32 s53, s50, 616448
    buffer_load_dwordx4 v20, s[28:31], s53 offen lds
    s_add_u32 m0, s51, 58368
    s_add_u32 s53, s50, 627456
    buffer_load_dwordx4 v20, s[28:31], s53 offen lds
    s_add_u32 m0, s51, 61440
    s_add_u32 s53, s50, 660480
    buffer_load_dwordx4 v20, s[28:31], s53 offen lds
    s_add_u32 m0, s51, 62464
    s_add_u32 s53, s50, 671488
    buffer_load_dwordx4 v20, s[28:31], s53 offen lds
    s_waitcnt vmcnt(13)
    s_barrier
    s_add_u32 m0, s49, 16384
    s_movk_i32 s52, 512
    buffer_load_dwordx4 v16, s[24:27], s52 offen lds
    s_add_u32 m0, s51, 81920
    s_add_u32 s53, s50, 704512
    buffer_load_dwordx4 v20, s[28:31], s53 offen lds
    s_mov_b32 s56, 0
L_HF_NCHK:
    v_readfirstlane_b32 s92, v32
    v_readfirstlane_b32 s93, v33
    s_add_u32 s56, s56, 1
    s_cmp_ge_u32 s56, 32768
    s_cbranch_scc1 L_HF_NOK
    s_cmp_eq_u32 s92, 0
    s_cbranch_scc1 L_HF_NRE
    s_memrealtime s[40:41]
    s_waitcnt lgkmcnt(0)
    s_sub_u32 s41, s40, s92
    s_cmp_lt_i32 s41, 800
    s_cbranch_scc1 L_HF_NOK
    s_cmp_ge_u32 s56, 40
    s_cbranch_scc1 L_HF_NOK
L_HF_NRE:
    buffer_load_dwordx2 v[32:33], v35, s[88:91], 0 offen sc1
    s_waitcnt vmcnt(0)
    s_branch L_HF_NCHK
L_HF_NOK:
    s_getreg_b32 s100, hwreg(HW_REG_XCC_ID, 0, 4)
    s_lshl_b32 s53, s2, 7
    s_add_u32 s53, s53, 9502720
    s_cmp_eq_u32 s36, 0
    s_cselect_b32 s53, s53, 2130706432
    v_mov_b32 v36, s100
    v_mov_b32 v37, s92
    v_mov_b32 v38, 0
    s_mov_b64 exec, 1
    buffer_store_dwordx2 v[36:37], v38, s[32:35], s53 offen sc1
    s_mov_b64 exec, -1
    s_add_u32 m0, s49, 17408
    s_movk_i32 s52, 512
    buffer_load_dwordx4 v17, s[24:27], s52 offen lds
    s_add_u32 m0, s51, 82944
    s_add_u32 s53, s50, 715520
    buffer_load_dwordx4 v20, s[28:31], s53 offen lds
    s_add_u32 m0, s49, 18432
    s_movk_i32 s52, 512
    buffer_load_dwordx4 v18, s[24:27], s52 offen lds
    s_add_u32 m0, s51, 86016
    s_add_u32 s53, s50, 748544
    buffer_load_dwordx4 v20, s[28:31], s53 offen lds
    s_add_u32 m0, s49, 19456
    s_movk_i32 s52, 512
    buffer_load_dwordx4 v19, s[24:27], s52 offen lds
    s_add_u32 m0, s51, 87040
    s_add_u32 s53, s50, 759552
    buffer_load_dwordx4 v20, s[28:31], s53 offen lds
    s_add_u32 m0, s51, 90112
    s_add_u32 s53, s50, 792576
    buffer_load_dwordx4 v20, s[28:31], s53 offen lds
    s_add_u32 m0, s51, 91136
    s_add_u32 s53, s50, 803584
    buffer_load_dwordx4 v20, s[28:31], s53 offen lds
    s_add_u32 m0, s51, 94208
    s_add_u32 s53, s50, 836608
    buffer_load_dwordx4 v20, s[28:31], s53 offen lds
    s_add_u32 m0, s51, 95232
    s_add_u32 s53, s50, 847616
    buffer_load_dwordx4 v20, s[28:31], s53 offen lds
    s_waitcnt vmcnt(12)
    s_barrier
    s_add_u32 m0, s49, 32768
    s_movk_i32 s52, 640
    buffer_load_dwordx4 v16, s[24:27], s52 offen lds
    s_add_u32 m0, s51, 114688
    s_add_u32 s53, s50, 880640
    buffer_load_dwordx4 v20, s[28:31], s53 offen lds
    s_add_u32 m0, s49, 33792
    s_movk_i32 s52, 640
    buffer_load_dwordx4 v17, s[24:27], s52 offen lds
    s_add_u32 m0, s51, 115712
    s_add_u32 s53, s50, 891648
    buffer_load_dwordx4 v20, s[28:31], s53 offen lds
    s_add_u32 m0, s49, 34816
    s_movk_i32 s52, 640
    buffer_load_dwordx4 v18, s[24:27], s52 offen lds
    s_add_u32 m0, s51, 118784
    s_add_u32 s53, s50, 924672
    buffer_load_dwordx4 v20, s[28:31], s53 offen lds
    s_add_u32 m0, s49, 35840
    s_movk_i32 s52, 640
    buffer_load_dwordx4 v19, s[24:27], s52 offen lds
    s_add_u32 m0, s51, 119808
    s_add_u32 s53, s50, 935680
    buffer_load_dwordx4 v20, s[28:31], s53 offen lds
    s_add_u32 m0, s51, 122880
    s_add_u32 s53, s50, 968704
    buffer_load_dwordx4 v20, s[28:31], s53 offen lds
    s_add_u32 m0, s51, 123904
    s_add_u32 s53, s50, 979712
    buffer_load_dwordx4 v20, s[28:31], s53 offen lds
    s_add_u32 m0, s51, 126976
    s_add_u32 s53, s50, 1012736
    buffer_load_dwordx4 v20, s[28:31], s53 offen lds
    s_add_u32 m0, s51, 128000
    s_add_u32 s53, s50, 1023744
    buffer_load_dwordx4 v20, s[28:31], s53 offen lds
    s_waitcnt vmcnt(12)
    s_barrier
    s_add_u32 m0, s49, 0
    s_movk_i32 s52, 768
    buffer_load_dwordx4 v16, s[24:27], s52 offen lds
    s_add_u32 m0, s51, 49152
    s_add_u32 s53, s50, 1056768
    buffer_load_dwordx4 v20, s[28:31], s53 offen lds
    s_add_u32 m0, s49, 1024
    s_movk_i32 s52, 768
    buffer_load_dwordx4 v17, s[24:27], s52 offen lds
    s_add_u32 m0, s51, 50176
    s_add_u32 s53, s50, 1067776
    buffer_load_dwordx4 v20, s[28:31], s53 offen lds
    s_add_u32 m0, s49, 2048
    s_movk_i32 s52, 768
    buffer_load_dwordx4 v18, s[24:27], s52 offen lds
    s_add_u32 m0, s51, 53248
    s_add_u32 s53, s50, 1100800
    buffer_load_dwordx4 v20, s[28:31], s53 offen lds
    s_add_u32 m0, s49, 3072
    s_movk_i32 s52, 768
    buffer_load_dwordx4 v19, s[24:27], s52 offen lds
    s_add_u32 m0, s51, 54272
    s_add_u32 s53, s50, 1111808
    buffer_load_dwordx4 v20, s[28:31], s53 offen lds
    s_add_u32 m0, s51, 57344
    s_add_u32 s53, s50, 1144832
    buffer_load_dwordx4 v20, s[28:31], s53 offen lds
    s_add_u32 m0, s51, 58368
    s_add_u32 s53, s50, 1155840
    buffer_load_dwordx4 v20, s[28:31], s53 offen lds
    s_add_u32 m0, s51, 61440
    s_add_u32 s53, s50, 1188864
    buffer_load_dwordx4 v20, s[28:31], s53 offen lds
    s_add_u32 m0, s51, 62464
    s_add_u32 s53, s50, 1199872
    buffer_load_dwordx4 v20, s[28:31], s53 offen lds
    s_waitcnt vmcnt(12)
    s_barrier
    s_add_u32 m0, s49, 16384
    s_movk_i32 s52, 896
    buffer_load_dwordx4 v16, s[24:27], s52 offen lds
    s_add_u32 m0, s51, 81920
    s_add_u32 s53, s50, 1232896
    buffer_load_dwordx4 v20, s[28:31], s53 offen lds
    s_add_u32 m0, s49, 17408
    s_movk_i32 s52, 896
    buffer_load_dwordx4 v17, s[24:27], s52 offen lds
    s_add_u32 m0, s51, 82944
    s_add_u32 s53, s50, 1243904
    buffer_load_dwordx4 v20, s[28:31], s53 offen lds
    s_add_u32 m0, s49, 18432
    s_movk_i32 s52, 896
    buffer_load_dwordx4 v18, s[24:27], s52 offen lds
    s_add_u32 m0, s51, 86016
    s_add_u32 s53, s50, 1276928
    buffer_load_dwordx4 v20, s[28:31], s53 offen lds
    s_add_u32 m0, s49, 19456
    s_movk_i32 s52, 896
    buffer_load_dwordx4 v19, s[24:27], s52 offen lds
    s_add_u32 m0, s51, 87040
    s_add_u32 s53, s50, 1287936
    buffer_load_dwordx4 v20, s[28:31], s53 offen lds
    s_add_u32 m0, s51, 90112
    s_add_u32 s53, s50, 1320960
    buffer_load_dwordx4 v20, s[28:31], s53 offen lds
    s_add_u32 m0, s51, 91136
    s_add_u32 s53, s50, 1331968
    buffer_load_dwordx4 v20, s[28:31], s53 offen lds
    s_add_u32 m0, s51, 94208
    s_add_u32 s53, s50, 1364992
    buffer_load_dwordx4 v20, s[28:31], s53 offen lds
    s_add_u32 m0, s51, 95232
    s_add_u32 s53, s50, 1376000
    buffer_load_dwordx4 v20, s[28:31], s53 offen lds
    s_waitcnt vmcnt(12)
    s_barrier
    v_and_b32 v44, 31, v0
    s_lshl_b32 s37, s36, 5
    v_add_u32 v45, s37, v44
    s_lshl_b32 s38, s22, 7
    v_add_u32 v46, s38, v45
    v_lshlrev_b32 v46, 4, v46
    s_mov_b32 s37, 9437184
    buffer_load_dwordx4 v[36:39], v46, s[32:35], s37 offen sc1
    s_lshl_b32 s38, s74, 9
    s_add_u32 s38, s38, 9535488
    v_and_b32 v51, 3, v0
    v_lshlrev_b32 v51, 7, v51
    buffer_load_dword v51, v51, s[32:35], s38 offen sc1
    s_lshl_b32 s57, s23, 11
    s_lshl_b32 s58, s36, 9
    s_add_u32 s57, s57, s58
    s_add_u32 s57, s57, 9478144
    v_lshlrev_b32 v47, 3, v0
    v_bfe_u32 v48, v0, 3, 1
    s_and_b32 s58, s22, 1
    s_lshl_b32 s58, s58, 1
    v_add_u32 v48, s58, v48
    v_lshlrev_b32 v48, 3, v48
    v_and_b32 v49, 7, v0
    v_add_u32 v48, v48, v49
    v_lshlrev_b32 v48, 10, v48
    s_lshr_b32 s58, s22, 1
    s_lshl_b32 s58, s58, 7
    s_add_u32 s58, s58, 9502720
    buffer_load_dwordx2 v[42:43], v48, s[32:35], s58 offen sc1
    buffer_load_dwordx2 v[40:41], v47, s[32:35], s57 offen sc1
    s_add_u32 m0, s72, 114688
    s_add_u32 s53, s94, 0
    buffer_load_dwordx4 v4, s[84:87], s53 offen lds
    s_add_u32 m0, s72, 115712
    s_add_u32 s53, s94, 8192
    buffer_load_dwordx4 v4, s[84:87], s53 offen lds
    s_add_u32 m0, s72, 116736
    s_add_u32 s53, s94, 65536
    buffer_load_dwordx4 v4, s[84:87], s53 offen lds
    s_add_u32 m0, s72, 117760
    s_add_u32 s53, s94, 73728
    buffer_load_dwordx4 v4, s[84:87], s53 offen lds
    s_waitcnt vmcnt(8)
    s_mov_b64 exec, 1
    ds_add_u32 v56, v57 offset:4
    s_mov_b64 exec, -1
    s_add_u32 m0, s72, 118784
    s_add_u32 s53, s94, 131072
    buffer_load_dwordx4 v4, s[84:87], s53 offen lds
    s_add_u32 m0, s72, 119808
    s_add_u32 s53, s94, 139264
    buffer_load_dwordx4 v4, s[84:87], s53 offen lds
    s_add_u32 m0, s70, 147456
    s_add_u32 s53, s94, 196608
    buffer_load_dwordx4 v4, s[84:87], s53 offen lds
    s_add_u32 m0, s70, 148480
    s_add_u32 s53, s94, 204800
    buffer_load_dwordx4 v4, s[84:87], s53 offen lds
    s_add_u32 m0, s71, 32768
    s_add_u32 s53, s94, 262144
    buffer_load_dwordx4 v4, s[84:87], s53 offen lds
    s_add_u32 m0, s71, 33792
    s_add_u32 s53, s94, 270336
    buffer_load_dwordx4 v4, s[84:87], s53 offen lds
    s_add_u32 m0, s71, 34816
    s_add_u32 s53, s96, 327680
    buffer_load_dwordx4 v4, s[84:87], s53 offen lds
    s_add_u32 m0, s71, 35840
    s_add_u32 s53, s96, 335872
    buffer_load_dwordx4 v4, s[84:87], s53 offen lds
    s_add_u32 m0, s72, 120832
    s_add_u32 s53, s95, 16384
    buffer_load_dwordx4 v4, s[84:87], s53 offen lds
    s_add_u32 m0, s72, 121856
    s_add_u32 s53, s95, 24576
    buffer_load_dwordx4 v4, s[84:87], s53 offen lds
    s_waitcnt vmcnt(14)
    s_mov_b32 s56, 0
L_HF_STCHK:
    v_cmp_eq_u32 vcc, s92, v38
    v_cmp_eq_u32 s[38:39], s93, v39
    v_cmp_eq_u32 s[44:45], s92, v41
    s_add_u32 s56, s56, 1
    s_nop 2
    s_and_b64 vcc, vcc, s[38:39]
    s_and_b64 vcc, vcc, s[44:45]
    s_cmp_eq_u64 vcc, -1
    s_cbranch_scc1 L_HF_STOK
    s_cmp_ge_u32 s56, 32768
    s_cbranch_scc1 L_HF_STOK
    buffer_load_dwordx4 v[36:39], v46, s[32:35], s37 offen sc1
    buffer_load_dwordx2 v[40:41], v47, s[32:35], s57 offen sc1
    s_waitcnt vmcnt(0)
    s_branch L_HF_STCHK
L_HF_STOK:
    v_rcp_f32 v44, v37
    v_mul_f32 v66, v37, v37
    v_lshlrev_b32 v45, 5, v45
    v_mul_f32 v62, 0xc0135761, v44
    v_mul_f32 v64, v44, v44
    v_mul_f32 v64, 0x3d372713, v64
    v_mul_f32 v64, v64, v62
    v_mov_b32 v60, v36
    v_mov_b32 v61, v36
    v_mov_b32 v63, v62
    v_mov_b32 v65, v64
    v_mov_b32 v67, v66
    v_add_u32 v45, 155648, v45
    ds_write_b128 v45, v[60:63]
    ds_write_b128 v45, v[64:67] offset:16
    v_lshrrev_b32 v45, 4, v0
    v_lshlrev_b32 v45, 7, v45
    s_and_b32 s38, s36, 1
    s_lshl_b32 s38, s38, 9
    s_lshr_b32 s39, s36, 1
    s_lshl_b32 s39, s39, 6
    s_add_u32 s38, s38, s39
    s_add_u32 s38, s38, 161792
    v_and_b32 v46, 15, v0
    v_lshl_add_u32 v45, v46, 2, v45
    v_add_u32 v45, s38, v45
    ds_write_b32 v45, v40
    v_cmp_eq_u32 vcc, s92, v43
    v_cmp_eq_u32 s[38:39], s100, v42
    v_mov_b32 v44, 162832
    v_mov_b32 v49, s92
    v_mov_b32 v50, s93
    s_nop 0
    s_and_b64 vcc, vcc, s[38:39]
    s_cmp_eq_u64 vcc, -1
    s_cselect_b32 s38, 1, 0
    v_mov_b32 v48, s38
    s_cmp_eq_u32 s36, 0
    s_cselect_b64 exec, 1, 0
    ds_write_b96 v44, v[48:50]
    s_mov_b64 exec, -1
    s_waitcnt lgkmcnt(0)
    s_mov_b64 exec, 1
    ds_add_u32 v56, v57 offset:4
    s_mov_b64 exec, -1
    s_waitcnt vmcnt(8)
    ds_read_b64_tr_b16 v[152:153], v12 offset:0
    ds_read_b64_tr_b16 v[154:155], v12 offset:512
    ds_read_b64_tr_b16 v[156:157], v13 offset:0
    ds_read_b64_tr_b16 v[158:159], v13 offset:512
    ds_read_b64_tr_b16 v[160:161], v12 offset:2048
    ds_read_b64_tr_b16 v[162:163], v12 offset:2560
    ds_read_b64_tr_b16 v[164:165], v13 offset:2048
    ds_read_b64_tr_b16 v[166:167], v13 offset:2560
    ds_read_b64_tr_b16 v[168:169], v12 offset:4096
    ds_read_b64_tr_b16 v[170:171], v12 offset:4608
    ds_read_b64_tr_b16 v[172:173], v13 offset:4096
    ds_read_b64_tr_b16 v[174:175], v13 offset:4608
    s_mov_b32 s44, 0
L_CA4:
    ds_read_b32 v58, v56
    s_add_u32 s44, s44, 1
    s_waitcnt lgkmcnt(0)
    v_readfirstlane_b32 s45, v58
    s_cmp_ge_u32 s44, 524288
    s_cbranch_scc1 L_CA4_OK
    s_cmp_lt_u32 s45, 4
    s_cbranch_scc1 L_CA4
L_CA4_OK:
    s_add_u32 m0, s71, 0
    s_add_u32 s53, s95, 81920
    buffer_load_dwordx4 v4, s[84:87], s53 offen lds
    s_add_u32 m0, s71, 1024
    s_add_u32 s53, s95, 90112
    buffer_load_dwordx4 v4, s[84:87], s53 offen lds
    s_add_u32 m0, s71, 2048
    s_add_u32 s53, s95, 147456
    buffer_load_dwordx4 v4, s[84:87], s53 offen lds
    s_add_u32 m0, s71, 3072
    s_add_u32 s53, s95, 155648
    buffer_load_dwordx4 v4, s[84:87], s53 offen lds
    s_add_u32 m0, s72, 49152
    s_add_u32 s53, s95, 212992
    buffer_load_dwordx4 v4, s[84:87], s53 offen lds
    s_add_u32 m0, s72, 50176
    s_add_u32 s53, s95, 221184
    buffer_load_dwordx4 v4, s[84:87], s53 offen lds
    s_add_u32 m0, s72, 51200
    s_add_u32 s53, s96, 278528
    buffer_load_dwordx4 v4, s[84:87], s53 offen lds
    s_add_u32 m0, s72, 52224
    s_add_u32 s53, s96, 286720
    buffer_load_dwordx4 v4, s[84:87], s53 offen lds
    s_add_u32 m0, s72, 114688
    s_add_u32 s53, s96, 344064
    buffer_load_dwordx4 v4, s[84:87], s53 offen lds
    s_add_u32 m0, s72, 115712
    s_add_u32 s53, s96, 352256
    buffer_load_dwordx4 v4, s[84:87], s53 offen lds
    s_add_u32 m0, s72, 116736
    s_add_u32 s53, s95, 32768
    buffer_load_dwordx4 v4, s[84:87], s53 offen lds
    s_add_u32 m0, s72, 117760
    s_add_u32 s53, s95, 40960
    buffer_load_dwordx4 v4, s[84:87], s53 offen lds
    s_add_u32 m0, s72, 118784
    s_add_u32 s53, s95, 98304
    buffer_load_dwordx4 v4, s[84:87], s53 offen lds
    s_add_u32 m0, s72, 119808
    s_add_u32 s53, s95, 106496
    buffer_load_dwordx4 v4, s[84:87], s53 offen lds
    s_add_u32 m0, s72, 53248
    s_add_u32 s53, s95, 163840
    buffer_load_dwordx4 v4, s[84:87], s53 offen lds
    s_add_u32 m0, s72, 54272
    s_add_u32 s53, s95, 172032
    buffer_load_dwordx4 v4, s[84:87], s53 offen lds
    s_add_u32 m0, s72, 55296
    s_add_u32 s53, s95, 229376
    buffer_load_dwordx4 v4, s[84:87], s53 offen lds
    s_add_u32 m0, s72, 56320
    s_add_u32 s53, s95, 237568
    buffer_load_dwordx4 v4, s[84:87], s53 offen lds
    s_mov_b32 s44, 0
L_CA8:
    ds_read_b32 v58, v56
    s_add_u32 s44, s44, 1
    s_waitcnt lgkmcnt(0)
    v_readfirstlane_b32 s45, v58
    s_cmp_ge_u32 s44, 524288
    s_cbranch_scc1 L_CA8_OK
    s_cmp_lt_u32 s45, 8
    s_cbranch_scc1 L_CA8
L_CA8_OK:
    s_add_u32 m0, s71, 16384
    s_add_u32 s53, s96, 294912
    buffer_load_dwordx4 v4, s[84:87], s53 offen lds
    s_add_u32 m0, s71, 17408
    s_add_u32 s53, s96, 303104
    buffer_load_dwordx4 v4, s[84:87], s53 offen lds
    s_add_u32 m0, s71, 18432
    s_add_u32 s53, s94, 49152
    buffer_load_dwordx4 v4, s[84:87], s53 offen lds
    s_add_u32 m0, s71, 19456
    s_add_u32 s53, s94, 57344
    buffer_load_dwordx4 v4, s[84:87], s53 offen lds
    s_add_u32 m0, s72, 81920
    s_add_u32 s53, s94, 114688
    buffer_load_dwordx4 v4, s[84:87], s53 offen lds
    s_add_u32 m0, s72, 82944
    s_add_u32 s53, s94, 122880
    buffer_load_dwordx4 v4, s[84:87], s53 offen lds
    s_add_u32 m0, s72, 83968
    s_add_u32 s53, s94, 180224
    buffer_load_dwordx4 v4, s[84:87], s53 offen lds
    s_add_u32 m0, s72, 84992
    s_add_u32 s53, s94, 188416
    buffer_load_dwordx4 v4, s[84:87], s53 offen lds
    s_add_u32 m0, s72, 86016
    s_add_u32 s53, s94, 245760
    buffer_load_dwordx4 v4, s[84:87], s53 offen lds
    s_add_u32 m0, s72, 87040
    s_add_u32 s53, s94, 253952
    buffer_load_dwordx4 v4, s[84:87], s53 offen lds
    s_add_u32 m0, s72, 88064
    s_add_u32 s53, s94, 311296
    buffer_load_dwordx4 v4, s[84:87], s53 offen lds
    s_add_u32 m0, s72, 89088
    s_add_u32 s53, s94, 319488
    buffer_load_dwordx4 v4, s[84:87], s53 offen lds
    s_branch L_P2
L_HD:
    s_and_b32 s37, s36, 1
    s_lshl_b32 s37, s37, 5
    s_lshl_b32 s38, s23, 6
    s_add_u32 s37, s37, s38
    v_add_u32 v2, s37, v2
    v_lshl_add_u32 v20, v2, 10, v4
    v_xor_b32 v5, 64, v20
    v_add_u32 v21, 0x2000, v5
    v_add_u32 v22, 0x4000, v20
    v_add_u32 v23, 0x6000, v5
    s_cmp_lt_u32 s36, 2
    s_cselect_b32 s38, 0x40000, 0
    v_cmp_eq_u32 vcc, 0, v2
    v_mov_b32 v5, s38
    s_nop 0
    v_cndmask_b32 v5, 0, v5, vcc
    v_add_u32 v20, v20, v5
    s_cmp_lt_u32 s36, 2
    s_waitcnt lgkmcnt(0)
    s_cselect_b32 s28, s8, s10
    s_cselect_b32 s29, s9, s11
    s_mov_b32 s30, 524288
    s_mov_b32 s31, 0x00020000
    s_mov_b32 s24, s4
    s_mov_b32 s25, s5
    s_mov_b32 s26, 2097152
    s_mov_b32 s27, 0x00020000
    s_mov_b32 s59, 2130706432
    s_add_u32 m0, s49, 0
    s_movk_i32 s52, 0
    buffer_load_dwordx4 v16, s[24:27], s52 offen lds
    s_add_u32 m0, s49, 49152
    s_nop 0
    buffer_load_dwordx4 v20, s[28:31], s52 offen lds
    s_add_u32 m0, s49, 1024
    s_movk_i32 s52, 0
    buffer_load_dwordx4 v17, s[24:27], s52 offen lds
    s_add_u32 m0, s49, 50176
    s_nop 0
    buffer_load_dwordx4 v21, s[28:31], s52 offen lds
    s_add_u32 m0, s49, 2048
    s_movk_i32 s52, 0
    buffer_load_dwordx4 v18, s[24:27], s52 offen lds
    s_add_u32 m0, s49, 51200
    s_nop 0
    buffer_load_dwordx4 v22, s[28:31], s52 offen lds
    s_add_u32 m0, s49, 3072
    s_movk_i32 s52, 0
    buffer_load_dwordx4 v19, s[24:27], s52 offen lds
    s_add_u32 m0, s49, 52224
    s_nop 0
    buffer_load_dwordx4 v23, s[28:31], s52 offen lds
    s_add_u32 m0, s49, 16384
    s_movk_i32 s52, 128
    buffer_load_dwordx4 v16, s[24:27], s52 offen lds
    s_add_u32 m0, s49, 65536
    s_nop 0
    buffer_load_dwordx4 v20, s[28:31], s52 offen lds
    s_mov_b32 s24, s4
    s_mov_b32 s25, s5
    s_mov_b32 s26, 2097152
    s_mov_b32 s27, 0x00020000
    s_mov_b32 s32, s16
    s_mov_b32 s33, s17
    s_mov_b32 s34, 10485760
    s_mov_b32 s35, 0x00020000
    s_mov_b32 s88, s80
    s_mov_b32 s89, s81
    s_mov_b32 s90, 256
    s_mov_b32 s91, 0x00020000
    s_add_u32 m0, s49, 17408
    s_movk_i32 s52, 128
    buffer_load_dwordx4 v17, s[24:27], s52 offen lds
    s_lshl_b32 s70, s36, 11
    s_lshl_b32 s71, s36, 12
    s_lshl_b32 s72, s36, 13
    s_mul_i32 s73, s36, 22
    s_and_b32 s53, s36, 1
    s_mul_i32 s97, s53, 2
    s_mul_i32 s98, s53, 6
    s_mul_i32 s99, s53, -17
    s_add_u32 s97, s97, s73
    s_add_u32 s98, s98, s73
    s_add_u32 s99, s99, s73
    s_lshl_b32 s94, s97, 14
    s_lshl_b32 s95, s98, 14
    s_lshl_b32 s96, s99, 14
    s_lshl_b32 s97, s97, 10
    s_lshl_b32 s98, s98, 10
    s_lshl_b32 s99, s99, 10
    s_and_b32 s74, s2, 7
    s_lshl_b32 s74, s74, 2
    s_lshr_b32 s75, s2, 6
    s_add_u32 s74, s74, s75
    s_bfe_u32 s75, s2, 0x30003
    s_mov_b32 s84, s18
    s_mov_b32 s85, s19
    s_mov_b32 s86, 1409024
    s_mov_b32 s87, 0x00020000
    v_lshrrev_b32 v6, 3, v0
    v_and_b32 v7, 7, v0
    v_lshlrev_b32 v6, 10, v6
    v_lshl_add_u32 v6, v7, 4, v6
    v_and_b32 v7, 16, v0
    v_lshlrev_b32 v7, 2, v7
    v_xor_b32 v6, v6, v7
    s_lshl_b32 s53, s75, 7
    v_add_u32 v4, s53, v6
    s_add_u32 m0, s49, 66560
    s_nop 0
    buffer_load_dwordx4 v21, s[28:31], s52 offen lds
    s_mul_i32 s53, s74, 176128
    v_lshlrev_b32 v6, 4, v0
    v_add_u32 v2, s53, v6
    v_add_u32 v3, 88064, v2
    v_lshrrev_b32 v7, 5, v0
    v_bfe_u32 v6, v0, 2, 2
    v_lshl_add_u32 v7, v7, 3, v6
    v_lshlrev_b32 v7, 7, v7
    v_lshrrev_b32 v6, 1, v6
    v_lshl_add_u32 v7, v6, 6, v7
    v_bfe_u32 v6, v0, 4, 1
    v_lshl_add_u32 v7, v6, 5, v7
    v_and_b32 v6, 3, v0
    v_lshl_add_u32 v7, v6, 3, v7
    v_add_u32 v8, s71, v7
    s_add_u32 s53, s72, 49152
    v_add_u32 v10, s53, v7
    v_add_u32 v12, 65536, v10
    s_add_u32 s53, s70, 147456
    v_add_u32 v14, s53, v7
    v_xor_b32 v9, 64, v8
    v_xor_b32 v11, 64, v10
    v_xor_b32 v13, 64, v12
    v_xor_b32 v15, 64, v14
    s_add_u32 m0, s49, 18432
    s_movk_i32 s52, 128
    buffer_load_dwordx4 v18, s[24:27], s52 offen lds
    s_lshr_b32 s57, s2, 3
    s_sub_u32 s57, s57, 22
    s_mul_i32 s57, s57, 172
    s_mul_i32 s58, s36, 43
    s_add_u32 s57, s57, s58
    s_lshl_b32 s57, s57, 10
    v_lshlrev_b32 v24, 4, v0
    v_mov_b32 v26, 162816
    v_mov_b32 v25, 0
    ds_write_b32 v26, v25
    s_add_u32 m0, s49, 67584
    s_nop 0
    buffer_load_dwordx4 v22, s[28:31], s52 offen lds
    s_add_u32 m0, s49, 19456
    s_movk_i32 s52, 128
    buffer_load_dwordx4 v19, s[24:27], s52 offen lds
    s_add_u32 m0, s49, 68608
    s_nop 0
    buffer_load_dwordx4 v23, s[28:31], s52 offen lds
    s_waitcnt vmcnt(8)
    s_waitcnt lgkmcnt(0)
    s_barrier
    s_add_u32 m0, s49, 32768
    s_movk_i32 s52, 256
    buffer_load_dwordx4 v16, s[24:27], s52 offen lds
    s_add_u32 m0, s49, 81920
    s_nop 0
    buffer_load_dwordx4 v20, s[28:31], s52 offen lds
    s_sub_u32 s40, s3, 176
    s_lshl_b32 s40, s40, 1
    s_and_b32 s41, s36, 1
    s_add_u32 s40, s40, s41
    s_lshl_b32 s40, s40, 11
    s_add_u32 s40, s40, 512
    v_min_u32 v52, 11, v0
    v_and_b32 v53, 3, v52
    v_lshrrev_b32 v52, 2, v52
    v_lshlrev_b32 v52, 10, v52
    v_lshl_add_u32 v52, v53, 7, v52
    buffer_load_dword v53, v52, s[28:31], s40 offen
    s_add_u32 m0, s49, 33792
    s_movk_i32 s52, 256
    buffer_load_dwordx4 v17, s[24:27], s52 offen lds
    v_mov_b32 v35, 0
    buffer_load_dwordx2 v[32:33], v35, s[88:91], 0 offen sc1
    s_add_u32 m0, s49, 82944
    s_nop 0
    buffer_load_dwordx4 v21, s[28:31], s52 offen lds
    s_add_u32 m0, s72, 114688
    s_add_u32 s53, s94, 0
    buffer_load_dwordx4 v4, s[84:87], s53 offen lds
    s_add_u32 m0, s72, 115712
    s_add_u32 s53, s94, 8192
    buffer_load_dwordx4 v4, s[84:87], s53 offen lds
    s_add_u32 m0, s49, 34816
    s_movk_i32 s52, 256
    buffer_load_dwordx4 v18, s[24:27], s52 offen lds
    s_add_u32 m0, s49, 83968
    s_nop 0
    buffer_load_dwordx4 v22, s[28:31], s52 offen lds
    s_add_u32 m0, s49, 35840
    s_movk_i32 s52, 256
    buffer_load_dwordx4 v19, s[24:27], s52 offen lds
    s_add_u32 m0, s49, 84992
    s_nop 0
    buffer_load_dwordx4 v23, s[28:31], s52 offen lds
    s_waitcnt vmcnt(12)
    s_barrier
    s_add_u32 m0, s49, 0
    s_movk_i32 s52, 384
    buffer_load_dwordx4 v16, s[24:27], s52 offen lds
    s_add_u32 m0, s49, 49152
    s_nop 0
    buffer_load_dwordx4 v20, s[28:31], s52 offen lds
    s_lshl_b32 s40, s3, 2
    s_add_u32 s40, s40, s36
    s_mul_i32 s40, s40, 1536
    v_min_u32 v52, 11, v0
    v_lshlrev_b32 v52, 7, v52
    buffer_load_dword v54, v52, s[84:87], s40 offen
    s_add_u32 m0, s49, 1024
    s_movk_i32 s52, 384
    buffer_load_dwordx4 v17, s[24:27], s52 offen lds
    s_add_u32 m0, s72, 116736
    s_add_u32 s53, s94, 65536
    buffer_load_dwordx4 v4, s[84:87], s53 offen lds
    s_add_u32 m0, s72, 117760
    s_add_u32 s53, s94, 73728
    buffer_load_dwordx4 v4, s[84:87], s53 offen lds
    s_add_u32 m0, s49, 50176
    s_nop 0
    buffer_load_dwordx4 v21, s[28:31], s52 offen lds
    s_add_u32 m0, s49, 2048
    s_movk_i32 s52, 384
    buffer_load_dwordx4 v18, s[24:27], s52 offen lds
    s_add_u32 m0, s49, 51200
    s_nop 0
    buffer_load_dwordx4 v22, s[28:31], s52 offen lds
    s_add_u32 m0, s49, 3072
    s_movk_i32 s52, 384
    buffer_load_dwordx4 v19, s[24:27], s52 offen lds
    s_add_u32 m0, s49, 52224
    s_nop 0
    buffer_load_dwordx4 v23, s[28:31], s52 offen lds
    s_waitcnt vmcnt(11)
    s_barrier
    s_add_u32 m0, s49, 16384
    s_movk_i32 s52, 512
    buffer_load_dwordx4 v16, s[24:27], s52 offen lds
    s_add_u32 m0, s49, 65536
    s_nop 0
    buffer_load_dwordx4 v20, s[28:31], s52 offen lds
    s_mov_b32 s56, 0
L_HD_NCHK:
    v_readfirstlane_b32 s92, v32
    v_readfirstlane_b32 s93, v33
    s_add_u32 s56, s56, 1
    s_cmp_ge_u32 s56, 32768
    s_cbranch_scc1 L_HD_NOK
    s_cmp_eq_u32 s92, 0
    s_cbranch_scc1 L_HD_NRE
    s_memrealtime s[40:41]
    s_waitcnt lgkmcnt(0)
    s_sub_u32 s41, s40, s92
    s_cmp_lt_i32 s41, 800
    s_cbranch_scc1 L_HD_NOK
    s_cmp_ge_u32 s56, 40
    s_cbranch_scc1 L_HD_NOK
L_HD_NRE:
    buffer_load_dwordx2 v[32:33], v35, s[88:91], 0 offen sc1
    s_waitcnt vmcnt(0)
    s_branch L_HD_NCHK
L_HD_NOK:
    s_getreg_b32 s100, hwreg(HW_REG_XCC_ID, 0, 4)
    s_lshl_b32 s53, s2, 7
    s_add_u32 s53, s53, 9502720
    s_cmp_eq_u32 s36, 0
    s_cselect_b32 s53, s53, 2130706432
    v_mov_b32 v36, s100
    v_mov_b32 v37, s92
    v_mov_b32 v38, 0
    s_mov_b64 exec, 1
    buffer_store_dwordx2 v[36:37], v38, s[32:35], s53 offen sc1
    s_mov_b64 exec, -1
    s_add_u32 m0, s49, 17408
    s_movk_i32 s52, 512
    buffer_load_dwordx4 v17, s[24:27], s52 offen lds
    s_add_u32 m0, s72, 118784
    s_add_u32 s53, s94, 131072
    buffer_load_dwordx4 v4, s[84:87], s53 offen lds
    s_add_u32 m0, s72, 119808
    s_add_u32 s53, s94, 139264
    buffer_load_dwordx4 v4, s[84:87], s53 offen lds
    s_add_u32 m0, s49, 66560
    s_nop 0
    buffer_load_dwordx4 v21, s[28:31], s52 offen lds
    s_add_u32 m0, s49, 18432
    s_movk_i32 s52, 512
    buffer_load_dwordx4 v18, s[24:27], s52 offen lds
    s_add_u32 m0, s49, 67584
    s_nop 0
    buffer_load_dwordx4 v22, s[28:31], s52 offen lds
    s_add_u32 m0, s49, 19456
    s_movk_i32 s52, 512
    buffer_load_dwordx4 v19, s[24:27], s52 offen lds
    s_add_u32 m0, s49, 68608
    s_nop 0
    buffer_load_dwordx4 v23, s[28:31], s52 offen lds
    s_waitcnt vmcnt(10)
    s_barrier
    s_add_u32 m0, s49, 32768
    s_movk_i32 s52, 640
    buffer_load_dwordx4 v16, s[24:27], s52 offen lds
    s_add_u32 m0, s49, 81920
    s_nop 0
    buffer_load_dwordx4 v20, s[28:31], s52 offen lds
    s_add_u32 m0, s70, 147456
    s_add_u32 s53, s94, 196608
    buffer_load_dwordx4 v4, s[84:87], s53 offen lds
    s_add_u32 m0, s70, 148480
    s_add_u32 s53, s94, 204800
    buffer_load_dwordx4 v4, s[84:87], s53 offen lds
    s_add_u32 m0, s49, 33792
    s_movk_i32 s52, 640
    buffer_load_dwordx4 v17, s[24:27], s52 offen lds
    s_add_u32 m0, s49, 82944
    s_nop 0
    buffer_load_dwordx4 v21, s[28:31], s52 offen lds
    s_add_u32 m0, s49, 34816
    s_movk_i32 s52, 640
    buffer_load_dwordx4 v18, s[24:27], s52 offen lds
    s_add_u32 m0, s49, 83968
    s_nop 0
    buffer_load_dwordx4 v22, s[28:31], s52 offen lds
    s_add_u32 m0, s49, 35840
    s_movk_i32 s52, 640
    buffer_load_dwordx4 v19, s[24:27], s52 offen lds
    s_add_u32 m0, s49, 84992
    s_nop 0
    buffer_load_dwordx4 v23, s[28:31], s52 offen lds
    s_waitcnt vmcnt(10)
    s_barrier
    s_add_u32 m0, s49, 0
    s_movk_i32 s52, 768
    buffer_load_dwordx4 v16, s[24:27], s52 offen lds
    s_add_u32 m0, s49, 49152
    s_nop 0
    buffer_load_dwordx4 v20, s[28:31], s52 offen lds
    s_add_u32 m0, s72, 120832
    s_add_u32 s53, s95, 16384
    buffer_load_dwordx4 v4, s[84:87], s53 offen lds
    s_add_u32 m0, s72, 121856
    s_add_u32 s53, s95, 24576
    buffer_load_dwordx4 v4, s[84:87], s53 offen lds
    s_add_u32 m0, s49, 1024
    s_movk_i32 s52, 768
    buffer_load_dwordx4 v17, s[24:27], s52 offen lds
    s_add_u32 m0, s49, 50176
    s_nop 0
    buffer_load_dwordx4 v21, s[28:31], s52 offen lds
    s_add_u32 m0, s49, 2048
    s_movk_i32 s52, 768
    buffer_load_dwordx4 v18, s[24:27], s52 offen lds
    s_add_u32 m0, s49, 51200
    s_nop 0
    buffer_load_dwordx4 v22, s[28:31], s52 offen lds
    s_add_u32 m0, s49, 3072
    s_movk_i32 s52, 768
    buffer_load_dwordx4 v19, s[24:27], s52 offen lds
    s_add_u32 m0, s49, 52224
    s_nop 0
    buffer_load_dwordx4 v23, s[28:31], s52 offen lds
    s_waitcnt vmcnt(10)
    s_barrier
    s_add_u32 m0, s49, 16384
    s_movk_i32 s52, 896
    buffer_load_dwordx4 v16, s[24:27], s52 offen lds
    s_add_u32 m0, s49, 65536
    s_nop 0
    buffer_load_dwordx4 v20, s[28:31], s52 offen lds
    s_add_u32 m0, s49, 17408
    s_movk_i32 s52, 896
    buffer_load_dwordx4 v17, s[24:27], s52 offen lds
    s_add_u32 m0, s49, 66560
    s_nop 0
    buffer_load_dwordx4 v21, s[28:31], s52 offen lds
    s_add_u32 m0, s49, 18432
    s_movk_i32 s52, 896
    buffer_load_dwordx4 v18, s[24:27], s52 offen lds
    s_add_u32 m0, s49, 67584
    s_nop 0
    buffer_load_dwordx4 v22, s[28:31], s52 offen lds
    s_add_u32 m0, s49, 19456
    s_movk_i32 s52, 896
    buffer_load_dwordx4 v19, s[24:27], s52 offen lds
    s_add_u32 m0, s49, 68608
    s_nop 0
    buffer_load_dwordx4 v23, s[28:31], s52 offen lds
    s_waitcnt vmcnt(8)
    s_barrier
    v_and_b32 v44, 31, v0
    s_lshl_b32 s37, s36, 5
    v_add_u32 v45, s37, v44
    s_lshl_b32 s38, s22, 7
    v_add_u32 v46, s38, v45
    v_lshlrev_b32 v46, 4, v46
    s_mov_b32 s37, 9437184
    buffer_load_dwordx4 v[36:39], v46, s[32:35], s37 offen sc1
    s_lshl_b32 s38, s74, 9
    s_add_u32 s38, s38, 9535488
    v_and_b32 v51, 3, v0
    v_lshlrev_b32 v51, 7, v51
    buffer_load_dword v51, v51, s[32:35], s38 offen sc1
    s_waitcnt vmcnt(2)
    s_barrier
    s_waitcnt vmcnt(1)
    s_mov_b32 s56, 0
L_HD_STCHK:
    v_cmp_eq_u32 vcc, s92, v38
    v_cmp_eq_u32 s[38:39], s93, v39
    s_add_u32 s56, s56, 1
    s_nop 2
    s_and_b64 vcc, vcc, s[38:39]
    s_cmp_eq_u64 vcc, -1
    s_cbranch_scc1 L_HD_STOK
    s_cmp_ge_u32 s56, 32768
    s_cbranch_scc1 L_HD_STOK
    buffer_load_dwordx4 v[36:39], v46, s[32:35], s37 offen sc1
    s_waitcnt vmcnt(0)
    s_branch L_HD_STCHK
L_HD_STOK:
    v_rcp_f32 v44, v37
    v_lshlrev_b32 v45, 2, v45
    v_add_u32 v45, 159744, v45
    ds_write_b32 v45, v36
    ds_write_b32 v45, v44 offset:512
    s_waitcnt lgkmcnt(0)
    s_barrier
    ds_read_b64_tr_b16 v[152:153], v12 offset:0
    ds_read_b64_tr_b16 v[154:155], v12 offset:512
    ds_read_b64_tr_b16 v[156:157], v13 offset:0
    ds_read_b64_tr_b16 v[158:159], v13 offset:512
    ds_read_b64_tr_b16 v[160:161], v12 offset:2048
    ds_read_b64_tr_b16 v[162:163], v12 offset:2560
    ds_read_b64_tr_b16 v[164:165], v13 offset:2048
    ds_read_b64_tr_b16 v[166:167], v13 offset:2560
    ds_read_b64_tr_b16 v[168:169], v12 offset:4096
    ds_read_b64_tr_b16 v[170:171], v12 offset:4608
    ds_read_b64_tr_b16 v[172:173], v13 offset:4096
    ds_read_b64_tr_b16 v[174:175], v13 offset:4608
    s_add_u32 m0, s72, 88064
    s_add_u32 s53, s94, 311296
    buffer_load_dwordx4 v4, s[84:87], s53 offen lds
    s_add_u32 m0, s72, 89088
    s_add_u32 s53, s94, 319488
    buffer_load_dwordx4 v4, s[84:87], s53 offen lds
    s_add_u32 m0, s72, 86016
    s_add_u32 s53, s94, 245760
    buffer_load_dwordx4 v4, s[84:87], s53 offen lds
    s_add_u32 m0, s72, 87040
    s_add_u32 s53, s94, 253952
    buffer_load_dwordx4 v4, s[84:87], s53 offen lds
    s_add_u32 m0, s72, 83968
    s_add_u32 s53, s94, 180224
    buffer_load_dwordx4 v4, s[84:87], s53 offen lds
    s_add_u32 m0, s72, 84992
    s_add_u32 s53, s94, 188416
    buffer_load_dwordx4 v4, s[84:87], s53 offen lds
    s_add_u32 m0, s72, 81920
    s_add_u32 s53, s94, 114688
    buffer_load_dwordx4 v4, s[84:87], s53 offen lds
    s_add_u32 m0, s72, 82944
    s_add_u32 s53, s94, 122880
    buffer_load_dwordx4 v4, s[84:87], s53 offen lds
    s_add_u32 m0, s71, 18432
    s_add_u32 s53, s94, 49152
    buffer_load_dwordx4 v4, s[84:87], s53 offen lds
    s_add_u32 m0, s71, 19456
    s_add_u32 s53, s94, 57344
    buffer_load_dwordx4 v4, s[84:87], s53 offen lds
    s_add_u32 m0, s71, 16384
    s_add_u32 s53, s96, 294912
    buffer_load_dwordx4 v4, s[84:87], s53 offen lds
    s_add_u32 m0, s71, 17408
    s_add_u32 s53, s96, 303104
    buffer_load_dwordx4 v4, s[84:87], s53 offen lds
    s_add_u32 m0, s72, 55296
    s_add_u32 s53, s95, 229376
    buffer_load_dwordx4 v4, s[84:87], s53 offen lds
    s_add_u32 m0, s72, 56320
    s_add_u32 s53, s95, 237568
    buffer_load_dwordx4 v4, s[84:87], s53 offen lds
    s_add_u32 m0, s72, 53248
    s_add_u32 s53, s95, 163840
    buffer_load_dwordx4 v4, s[84:87], s53 offen lds
    s_add_u32 m0, s72, 54272
    s_add_u32 s53, s95, 172032
    buffer_load_dwordx4 v4, s[84:87], s53 offen lds
    s_add_u32 m0, s72, 51200
    s_add_u32 s53, s96, 278528
    buffer_load_dwordx4 v4, s[84:87], s53 offen lds
    s_add_u32 m0, s72, 52224
    s_add_u32 s53, s96, 286720
    buffer_load_dwordx4 v4, s[84:87], s53 offen lds
    s_add_u32 m0, s72, 49152
    s_add_u32 s53, s95, 212992
    buffer_load_dwordx4 v4, s[84:87], s53 offen lds
    s_add_u32 m0, s72, 50176
    s_add_u32 s53, s95, 221184
    buffer_load_dwordx4 v4, s[84:87], s53 offen lds
    s_add_u32 m0, s71, 2048
    s_add_u32 s53, s95, 147456
    buffer_load_dwordx4 v4, s[84:87], s53 offen lds
    s_add_u32 m0, s71, 3072
    s_add_u32 s53, s95, 155648
    buffer_load_dwordx4 v4, s[84:87], s53 offen lds
    s_add_u32 m0, s71, 0
    s_add_u32 s53, s95, 81920
    buffer_load_dwordx4 v4, s[84:87], s53 offen lds
    s_add_u32 m0, s71, 1024
    s_add_u32 s53, s95, 90112
    buffer_load_dwordx4 v4, s[84:87], s53 offen lds
    s_add_u32 m0, s71, 34816
    s_add_u32 s53, s96, 327680
    buffer_load_dwordx4 v4, s[84:87], s53 offen lds
    s_add_u32 m0, s71, 35840
    s_add_u32 s53, s96, 335872
    buffer_load_dwordx4 v4, s[84:87], s53 offen lds
    s_add_u32 m0, s71, 32768
    s_add_u32 s53, s94, 262144
    buffer_load_dwordx4 v4, s[84:87], s53 offen lds
    s_add_u32 m0, s71, 33792
    s_add_u32 s53, s94, 270336
    buffer_load_dwordx4 v4, s[84:87], s53 offen lds
    s_waitcnt lgkmcnt(0)
    s_add_u32 m0, s72, 118784
    s_add_u32 s53, s95, 98304
    buffer_load_dwordx4 v4, s[84:87], s53 offen lds
    s_add_u32 m0, s72, 119808
    s_add_u32 s53, s95, 106496
    buffer_load_dwordx4 v4, s[84:87], s53 offen lds
    s_add_u32 m0, s72, 116736
    s_add_u32 s53, s95, 32768
    buffer_load_dwordx4 v4, s[84:87], s53 offen lds
    s_add_u32 m0, s72, 117760
    s_add_u32 s53, s95, 40960
    buffer_load_dwordx4 v4, s[84:87], s53 offen lds
    s_add_u32 m0, s72, 114688
    s_add_u32 s53, s96, 344064
    buffer_load_dwordx4 v4, s[84:87], s53 offen lds
    s_add_u32 m0, s72, 115712
    s_add_u32 s53, s96, 352256
    buffer_load_dwordx4 v4, s[84:87], s53 offen lds
    s_branch L_P2
L_HI:
    s_waitcnt lgkmcnt(0)
    s_mov_b32 s24, s4
    s_mov_b32 s25, s5
    s_mov_b32 s26, 2097152
    s_mov_b32 s27, 0x00020000
    s_mov_b32 s32, s16
    s_mov_b32 s33, s17
    s_mov_b32 s34, 10485760
    s_mov_b32 s35, 0x00020000
    s_mov_b32 s88, s80
    s_mov_b32 s89, s81
    s_mov_b32 s90, 256
    s_mov_b32 s91, 0x00020000
    s_lshl_b32 s70, s36, 11
    s_lshl_b32 s71, s36, 12
    s_lshl_b32 s72, s36, 13
    s_mul_i32 s73, s36, 22
    s_and_b32 s53, s36, 1
    s_mul_i32 s97, s53, 2
    s_mul_i32 s98, s53, 6
    s_mul_i32 s99, s53, -17
    s_add_u32 s97, s97, s73
    s_add_u32 s98, s98, s73
    s_add_u32 s99, s99, s73
    s_lshl_b32 s94, s97, 14
    s_lshl_b32 s95, s98, 14
    s_lshl_b32 s96, s99, 14
    s_lshl_b32 s97, s97, 10
    s_lshl_b32 s98, s98, 10
    s_lshl_b32 s99, s99, 10
    s_and_b32 s74, s2, 7
    s_lshl_b32 s74, s74, 2
    s_lshr_b32 s75, s2, 6
    s_add_u32 s74, s74, s75
    s_bfe_u32 s75, s2, 0x30003
    s_mov_b32 s84, s18
    s_mov_b32 s85, s19
    s_mov_b32 s86, 1409024
    s_mov_b32 s87, 0x00020000
    v_lshrrev_b32 v6, 3, v0
    v_and_b32 v7, 7, v0
    v_lshlrev_b32 v6, 10, v6
    v_lshl_add_u32 v6, v7, 4, v6
    v_and_b32 v7, 16, v0
    v_lshlrev_b32 v7, 2, v7
    v_xor_b32 v6, v6, v7
    s_lshl_b32 s53, s75, 7
    v_add_u32 v4, s53, v6
    s_mul_i32 s53, s74, 176128
    v_lshlrev_b32 v6, 4, v0
    v_add_u32 v2, s53, v6
    v_add_u32 v3, 88064, v2
    v_lshrrev_b32 v7, 5, v0
    v_bfe_u32 v6, v0, 2, 2
    v_lshl_add_u32 v7, v7, 3, v6
    v_lshlrev_b32 v7, 7, v7
    v_lshrrev_b32 v6, 1, v6
    v_lshl_add_u32 v7, v6, 6, v7
    v_bfe_u32 v6, v0, 4, 1
    v_lshl_add_u32 v7, v6, 5, v7
    v_and_b32 v6, 3, v0
    v_lshl_add_u32 v7, v6, 3, v7
    v_add_u32 v8, s71, v7
    s_add_u32 s53, s72, 49152
    v_add_u32 v10, s53, v7
    v_add_u32 v12, 65536, v10
    s_add_u32 s53, s70, 147456
    v_add_u32 v14, s53, v7
    v_xor_b32 v9, 64, v8
    v_xor_b32 v11, 64, v10
    v_xor_b32 v13, 64, v12
    v_xor_b32 v15, 64, v14
    s_cmp_lt_u32 s23, 11
    s_cbranch_scc1 L_HI2
    v_mov_b32 v34, 0
    s_mov_b32 s56, 0
L_HI_N:
    buffer_load_dwordx2 v[32:33], v34, s[88:91], 0 offen sc1
    s_add_u32 s56, s56, 1
    s_waitcnt vmcnt(0)
    v_readfirstlane_b32 s92, v32
    v_readfirstlane_b32 s93, v33
    s_nop 1
    s_cmp_ge_u32 s56, 32768
    s_cbranch_scc1 L_HI_N_OK
    s_cmp_eq_u32 s92, 0
    s_cbranch_scc1 L_HI_N
    s_memrealtime s[40:41]
    s_waitcnt lgkmcnt(0)
    s_sub_u32 s41, s40, s92
    s_cmp_lt_i32 s41, 800
    s_cbranch_scc1 L_HI_N_OK
    s_cmp_ge_u32 s56, 40
    s_cbranch_scc1 L_HI_N_OK
    s_branch L_HI_N
L_HI_N_OK:
    s_getreg_b32 s100, hwreg(HW_REG_XCC_ID, 0, 4)
    s_lshl_b32 s53, s2, 7
    s_add_u32 s53, s53, 9502720
    s_cmp_eq_u32 s36, 0
    s_cselect_b32 s53, s53, 2130706432
    v_mov_b32 v36, s100
    v_mov_b32 v37, s92
    v_mov_b32 v38, 0
    s_mov_b64 exec, 1
    buffer_store_dwordx2 v[36:37], v38, s[32:35], s53 offen sc1
    s_mov_b64 exec, -1
L_HI2:
    s_add_u32 m0, s72, 114688
    s_add_u32 s53, s94, 0
    buffer_load_dwordx4 v4, s[84:87], s53 offen lds
    s_add_u32 m0, s72, 115712
    s_add_u32 s53, s94, 8192
    buffer_load_dwordx4 v4, s[84:87], s53 offen lds
    s_add_u32 m0, s72, 116736
    s_add_u32 s53, s94, 65536
    buffer_load_dwordx4 v4, s[84:87], s53 offen lds
    s_add_u32 m0, s72, 117760
    s_add_u32 s53, s94, 73728
    buffer_load_dwordx4 v4, s[84:87], s53 offen lds
    s_add_u32 m0, s72, 118784
    s_add_u32 s53, s94, 131072
    buffer_load_dwordx4 v4, s[84:87], s53 offen lds
    s_add_u32 m0, s72, 119808
    s_add_u32 s53, s94, 139264
    buffer_load_dwordx4 v4, s[84:87], s53 offen lds
    s_add_u32 m0, s72, 88064
    s_add_u32 s53, s94, 311296
    buffer_load_dwordx4 v4, s[84:87], s53 offen lds
    s_add_u32 m0, s72, 89088
    s_add_u32 s53, s94, 319488
    buffer_load_dwordx4 v4, s[84:87], s53 offen lds
    s_add_u32 m0, s72, 86016
    s_add_u32 s53, s94, 245760
    buffer_load_dwordx4 v4, s[84:87], s53 offen lds
    s_add_u32 m0, s72, 87040
    s_add_u32 s53, s94, 253952
    buffer_load_dwordx4 v4, s[84:87], s53 offen lds
    s_add_u32 m0, s72, 83968
    s_add_u32 s53, s94, 180224
    buffer_load_dwordx4 v4, s[84:87], s53 offen lds
    s_add_u32 m0, s72, 84992
    s_add_u32 s53, s94, 188416
    buffer_load_dwordx4 v4, s[84:87], s53 offen lds
    s_add_u32 m0, s72, 81920
    s_add_u32 s53, s94, 114688
    buffer_load_dwordx4 v4, s[84:87], s53 offen lds
    s_add_u32 m0, s72, 82944
    s_add_u32 s53, s94, 122880
    buffer_load_dwordx4 v4, s[84:87], s53 offen lds
    s_add_u32 m0, s71, 18432
    s_add_u32 s53, s94, 49152
    buffer_load_dwordx4 v4, s[84:87], s53 offen lds
    s_add_u32 m0, s71, 19456
    s_add_u32 s53, s94, 57344
    buffer_load_dwordx4 v4, s[84:87], s53 offen lds
    s_add_u32 m0, s71, 16384
    s_add_u32 s53, s96, 294912
    buffer_load_dwordx4 v4, s[84:87], s53 offen lds
    s_add_u32 m0, s71, 17408
    s_add_u32 s53, s96, 303104
    buffer_load_dwordx4 v4, s[84:87], s53 offen lds
    s_add_u32 m0, s72, 55296
    s_add_u32 s53, s95, 229376
    buffer_load_dwordx4 v4, s[84:87], s53 offen lds
    s_add_u32 m0, s72, 56320
    s_add_u32 s53, s95, 237568
    buffer_load_dwordx4 v4, s[84:87], s53 offen lds
    s_add_u32 m0, s72, 53248
    s_add_u32 s53, s95, 163840
    buffer_load_dwordx4 v4, s[84:87], s53 offen lds
    s_add_u32 m0, s72, 54272
    s_add_u32 s53, s95, 172032
    buffer_load_dwordx4 v4, s[84:87], s53 offen lds
    s_add_u32 m0, s72, 51200
    s_add_u32 s53, s96, 278528
    buffer_load_dwordx4 v4, s[84:87], s53 offen lds
    s_add_u32 m0, s72, 52224
    s_add_u32 s53, s96, 286720
    buffer_load_dwordx4 v4, s[84:87], s53 offen lds
    s_add_u32 m0, s72, 49152
    s_add_u32 s53, s95, 212992
    buffer_load_dwordx4 v4, s[84:87], s53 offen lds
    s_add_u32 m0, s72, 50176
    s_add_u32 s53, s95, 221184
    buffer_load_dwordx4 v4, s[84:87], s53 offen lds
    s_add_u32 m0, s71, 2048
    s_add_u32 s53, s95, 147456
    buffer_load_dwordx4 v4, s[84:87], s53 offen lds
    s_add_u32 m0, s71, 3072
    s_add_u32 s53, s95, 155648
    buffer_load_dwordx4 v4, s[84:87], s53 offen lds
    s_add_u32 m0, s71, 0
    s_add_u32 s53, s95, 81920
    buffer_load_dwordx4 v4, s[84:87], s53 offen lds
    s_add_u32 m0, s71, 1024
    s_add_u32 s53, s95, 90112
    buffer_load_dwordx4 v4, s[84:87], s53 offen lds
    s_add_u32 m0, s72, 120832
    s_add_u32 s53, s95, 16384
    buffer_load_dwordx4 v4, s[84:87], s53 offen lds
    s_add_u32 m0, s72, 121856
    s_add_u32 s53, s95, 24576
    buffer_load_dwordx4 v4, s[84:87], s53 offen lds
    s_add_u32 m0, s71, 34816
    s_add_u32 s53, s96, 327680
    buffer_load_dwordx4 v4, s[84:87], s53 offen lds
    s_add_u32 m0, s71, 35840
    s_add_u32 s53, s96, 335872
    buffer_load_dwordx4 v4, s[84:87], s53 offen lds
    s_add_u32 m0, s71, 32768
    s_add_u32 s53, s94, 262144
    buffer_load_dwordx4 v4, s[84:87], s53 offen lds
    s_add_u32 m0, s71, 33792
    s_add_u32 s53, s94, 270336
    buffer_load_dwordx4 v4, s[84:87], s53 offen lds
    s_add_u32 m0, s70, 147456
    s_add_u32 s53, s94, 196608
    buffer_load_dwordx4 v4, s[84:87], s53 offen lds
    s_add_u32 m0, s70, 148480
    s_add_u32 s53, s94, 204800
    buffer_load_dwordx4 v4, s[84:87], s53 offen lds
    s_waitcnt vmcnt(32)
    ds_read_b64_tr_b16 v[152:153], v12 offset:0
    ds_read_b64_tr_b16 v[154:155], v12 offset:512
    ds_read_b64_tr_b16 v[156:157], v13 offset:0
    ds_read_b64_tr_b16 v[158:159], v13 offset:512
    ds_read_b64_tr_b16 v[160:161], v12 offset:2048
    ds_read_b64_tr_b16 v[162:163], v12 offset:2560
    ds_read_b64_tr_b16 v[164:165], v13 offset:2048
    ds_read_b64_tr_b16 v[166:167], v13 offset:2560
    ds_read_b64_tr_b16 v[168:169], v12 offset:4096
    ds_read_b64_tr_b16 v[170:171], v12 offset:4608
    ds_read_b64_tr_b16 v[172:173], v13 offset:4096
    ds_read_b64_tr_b16 v[174:175], v13 offset:4608
    s_waitcnt lgkmcnt(0)
    s_add_u32 m0, s72, 114688
    s_add_u32 s53, s96, 344064
    buffer_load_dwordx4 v4, s[84:87], s53 offen lds
    s_add_u32 m0, s72, 115712
    s_add_u32 s53, s96, 352256
    buffer_load_dwordx4 v4, s[84:87], s53 offen lds
    s_add_u32 m0, s72, 116736
    s_add_u32 s53, s95, 32768
    buffer_load_dwordx4 v4, s[84:87], s53 offen lds
    s_add_u32 m0, s72, 117760
    s_add_u32 s53, s95, 40960
    buffer_load_dwordx4 v4, s[84:87], s53 offen lds
    s_add_u32 m0, s72, 118784
    s_add_u32 s53, s95, 98304
    buffer_load_dwordx4 v4, s[84:87], s53 offen lds
    s_add_u32 m0, s72, 119808
    s_add_u32 s53, s95, 106496
    buffer_load_dwordx4 v4, s[84:87], s53 offen lds
L_P2:
    s_and_b32 s53, s36, 1
    s_cmp_eq_u32 s53, 0
    s_cselect_b32 s44, 6, 5
    s_cselect_b32 s45, 12, 10
    s_cselect_b32 s46, 17, 16
    s_lshl_b32 s53, s53, 1
    v_min_u32 v130, 21, v0
    v_cmp_le_u32 vcc, s44, v130
    v_cmp_le_u32 s[38:39], s45, v130
    v_cmp_le_u32 s[48:49], s46, v130
    v_mov_b32 v128, 0
    v_mov_b32 v129, 0
    v_mov_b32 v131, s44
    v_cndmask_b32 v128, v128, v131, vcc
    v_addc_co_u32 v129, vcc, 0, v129, vcc
    v_mov_b32 v131, s45
    v_cndmask_b32 v128, v128, v131, s[38:39]
    v_addc_co_u32 v129, vcc, 0, v129, s[38:39]
    v_mov_b32 v131, s46
    v_cndmask_b32 v128, v128, v131, s[48:49]
    v_addc_co_u32 v129, vcc, 0, v129, s[48:49]
    v_sub_u32 v128, v130, v128
    v_add_u32 v129, s53, v129
    v_and_b32 v129, 3, v129
    v_lshl_add_u32 v128, v128, 2, v129
    v_add_u32 v128, s73, v128
    v_lshlrev_b32 v128, 2, v128
    s_lshl_b32 s55, s74, 9
    s_add_u32 s55, s55, 9535488
    s_cmp_eq_u32 s36, 3
    s_cselect_b32 s43, 2130706432, 0
    s_cselect_b32 s47, 2129920, 0
    s_mov_b32 s57, 0
    v_lshlrev_b32 v6, 4, v0
    s_add_u32 s53, s72, 49152
    v_add_u32 v7, s53, v6
    s_and_b32 s53, s47, 1023
    s_cmp_eq_u32 s53, 1023
    s_cbranch_scc0 L_NS0
L_NR0:
    s_add_u32 s53, s97, 0
    buffer_load_dwordx4 v[16:19], v2, s[32:35], s53 offen sc1
    buffer_load_dwordx4 v[20:23], v3, s[32:35], s53 offen sc1
    s_add_u32 s53, s97, 4096
    buffer_load_dwordx4 v[24:27], v2, s[32:35], s53 offen sc1
    buffer_load_dwordx4 v[28:31], v3, s[32:35], s53 offen sc1
    s_add_u32 s53, s97, 8192
    buffer_load_dwordx4 v[32:35], v2, s[32:35], s53 offen sc1
    buffer_load_dwordx4 v[36:39], v3, s[32:35], s53 offen sc1
    s_add_u32 s53, s97, 12288
    buffer_load_dwordx4 v[40:43], v2, s[32:35], s53 offen sc1
    buffer_load_dwordx4 v[44:47], v3, s[32:35], s53 offen sc1
    ds_read_b64_tr_b16 v[144:145], v14 offset:0
    ds_read_b64_tr_b16 v[146:147], v14 offset:512
    ds_read_b64_tr_b16 v[148:149], v15 offset:0
    ds_read_b64_tr_b16 v[150:151], v15 offset:512
    s_waitcnt vmcnt(6)
    v_mfma_f32_32x32x16_bf16 v[192:207], v[152:155], v[16:19], 0
    s_add_u32 s53, s97, 16384
    buffer_load_dwordx4 v[48:51], v2, s[32:35], s53 offen sc1
    v_mfma_f32_32x32x16_bf16 v[224:239], v[152:155], v[20:23], 0
    buffer_load_dwordx4 v[52:55], v3, s[32:35], s53 offen sc1
    v_mfma_f32_32x32x16_bf16 v[208:223], v[156:159], v[16:19], 0
    s_add_u32 s53, s99, 20480
    buffer_load_dwordx4 v[56:59], v2, s[32:35], s53 offen sc1
    v_mfma_f32_32x32x16_bf16 v[240:255], v[156:159], v[20:23], 0
    buffer_load_dwordx4 v[60:63], v3, s[32:35], s53 offen sc1
    s_waitcnt vmcnt(8)
    v_mfma_f32_32x32x16_bf16 v[192:207], v[160:163], v[24:27], v[192:207]
    s_add_u32 s53, s98, 1024
    buffer_load_dwordx4 v[64:67], v2, s[32:35], s53 offen sc1
    v_mfma_f32_32x32x16_bf16 v[224:239], v[160:163], v[28:31], v[224:239]
    buffer_load_dwordx4 v[68:71], v3, s[32:35], s53 offen sc1
    v_mfma_f32_32x32x16_bf16 v[208:223], v[164:167], v[24:27], v[208:223]
    s_add_u32 s53, s98, 5120
    buffer_load_dwordx4 v[72:75], v2, s[32:35], s53 offen sc1
    v_mfma_f32_32x32x16_bf16 v[240:255], v[164:167], v[28:31], v[240:255]
    buffer_load_dwordx4 v[76:79], v3, s[32:35], s53 offen sc1
    s_waitcnt vmcnt(10)
    v_mfma_f32_32x32x16_bf16 v[192:207], v[168:171], v[32:35], v[192:207]
    s_add_u32 s53, s98, 9216
    buffer_load_dwordx4 v[80:83], v2, s[32:35], s53 offen sc1
    v_mfma_f32_32x32x16_bf16 v[224:239], v[168:171], v[36:39], v[224:239]
    buffer_load_dwordx4 v[84:87], v3, s[32:35], s53 offen sc1
    v_mfma_f32_32x32x16_bf16 v[208:223], v[172:175], v[32:35], v[208:223]
    s_add_u32 s53, s98, 13312
    buffer_load_dwordx4 v[88:91], v2, s[32:35], s53 offen sc1
    v_mfma_f32_32x32x16_bf16 v[240:255], v[172:175], v[36:39], v[240:255]
    buffer_load_dwordx4 v[92:95], v3, s[32:35], s53 offen sc1
    buffer_load_dword v132, v128, s[32:35], s55 offen sc1
    s_waitcnt vmcnt(13)
    s_waitcnt lgkmcnt(0)
    v_mfma_f32_32x32x16_bf16 v[192:207], v[144:147], v[40:43], v[192:207]
    ds_read_b64_tr_b16 v[136:137], v8 offset:32768
    ds_read_b64_tr_b16 v[138:139], v8 offset:33280
    ds_read_b64_tr_b16 v[140:141], v9 offset:32768
    ds_read_b64_tr_b16 v[142:143], v9 offset:33280
    v_mfma_f32_32x32x16_bf16 v[224:239], v[144:147], v[44:47], v[224:239]
    v_mfma_f32_32x32x16_bf16 v[208:223], v[148:151], v[40:43], v[208:223]
    v_mfma_f32_32x32x16_bf16 v[240:255], v[148:151], v[44:47], v[240:255]
    s_waitcnt vmcnt(11)
    s_waitcnt lgkmcnt(0)
    v_mfma_f32_32x32x16_bf16 v[192:207], v[136:139], v[48:51], v[192:207]
    ds_read_b64_tr_b16 v[144:145], v8 offset:34816
    ds_read_b64_tr_b16 v[146:147], v8 offset:35328
    ds_read_b64_tr_b16 v[148:149], v9 offset:34816
    ds_read_b64_tr_b16 v[150:151], v9 offset:35328
    v_mfma_f32_32x32x16_bf16 v[224:239], v[136:139], v[52:55], v[224:239]
    v_mfma_f32_32x32x16_bf16 v[208:223], v[140:143], v[48:51], v[208:223]
    v_mfma_f32_32x32x16_bf16 v[240:255], v[140:143], v[52:55], v[240:255]
    s_waitcnt vmcnt(9)
    s_waitcnt lgkmcnt(0)
    v_mfma_f32_32x32x16_bf16 v[192:207], v[144:147], v[56:59], v[192:207]
    ds_read_b64_tr_b16 v[136:137], v12 offset:6144
    ds_read_b64_tr_b16 v[138:139], v12 offset:6656
    ds_read_b64_tr_b16 v[140:141], v13 offset:6144
    ds_read_b64_tr_b16 v[142:143], v13 offset:6656
    s_waitcnt vmcnt(0)
    v_cmp_eq_u32 vcc, s92, v132
    s_nop 3
    s_or_b32 s47, s47, vcc_lo
    s_and_b32 s53, s47, 4194303
    s_cmp_eq_u32 s53, 4194303
    s_cbranch_scc0 L_NS10
L_NR10:
    s_add_u32 s53, s99, 17408
    buffer_load_dwordx4 v[96:99], v2, s[32:35], s53 offen sc1
    v_mfma_f32_32x32x16_bf16 v[224:239], v[144:147], v[60:63], v[224:239]
    buffer_load_dwordx4 v[100:103], v3, s[32:35], s53 offen sc1
    v_mfma_f32_32x32x16_bf16 v[208:223], v[148:151], v[56:59], v[208:223]
    s_add_u32 s53, s99, 21504
    buffer_load_dwordx4 v[104:107], v2, s[32:35], s53 offen sc1
    v_mfma_f32_32x32x16_bf16 v[240:255], v[148:151], v[60:63], v[240:255]
    buffer_load_dwordx4 v[108:111], v3, s[32:35], s53 offen sc1
    s_waitcnt lgkmcnt(0)
    v_mfma_f32_32x32x16_bf16 v[192:207], v[136:139], v[64:67], v[192:207]
    ds_read_b64_tr_b16 v[144:145], v8 offset:0
    ds_read_b64_tr_b16 v[146:147], v8 offset:512
    ds_read_b64_tr_b16 v[148:149], v9 offset:0
    ds_read_b64_tr_b16 v[150:151], v9 offset:512
    s_add_u32 s53, s98, 2048
    buffer_load_dwordx4 v[16:19], v2, s[32:35], s53 offen sc1
    v_mfma_f32_32x32x16_bf16 v[224:239], v[136:139], v[68:71], v[224:239]
    buffer_load_dwordx4 v[20:23], v3, s[32:35], s53 offen sc1
    v_mfma_f32_32x32x16_bf16 v[208:223], v[140:143], v[64:67], v[208:223]
    s_add_u32 s53, s98, 6144
    buffer_load_dwordx4 v[24:27], v2, s[32:35], s53 offen sc1
    v_mfma_f32_32x32x16_bf16 v[240:255], v[140:143], v[68:71], v[240:255]
    buffer_load_dwordx4 v[28:31], v3, s[32:35], s53 offen sc1
    s_waitcnt lgkmcnt(0)
    v_mfma_f32_32x32x16_bf16 v[192:207], v[144:147], v[72:75], v[192:207]
    ds_read_b64_tr_b16 v[136:137], v8 offset:2048
    ds_read_b64_tr_b16 v[138:139], v8 offset:2560
    ds_read_b64_tr_b16 v[140:141], v9 offset:2048
    ds_read_b64_tr_b16 v[142:143], v9 offset:2560
    s_add_u32 s53, s98, 10240
    buffer_load_dwordx4 v[32:35], v2, s[32:35], s53 offen sc1
    v_mfma_f32_32x32x16_bf16 v[224:239], v[144:147], v[76:79], v[224:239]
    buffer_load_dwordx4 v[36:39], v3, s[32:35], s53 offen sc1
    v_mfma_f32_32x32x16_bf16 v[208:223], v[148:151], v[72:75], v[208:223]
    s_add_u32 s53, s98, s43
    s_add_u32 s53, s53, 14336
    buffer_load_dwordx4 v[40:43], v2, s[32:35], s53 offen sc1
    v_mfma_f32_32x32x16_bf16 v[240:255], v[148:151], v[76:79], v[240:255]
    buffer_load_dwordx4 v[44:47], v3, s[32:35], s53 offen sc1
    s_waitcnt lgkmcnt(0)
    v_mfma_f32_32x32x16_bf16 v[192:207], v[136:139], v[80:83], v[192:207]
    ds_read_b64_tr_b16 v[144:145], v10 offset:0
    ds_read_b64_tr_b16 v[146:147], v10 offset:512
    ds_read_b64_tr_b16 v[148:149], v11 offset:0
    ds_read_b64_tr_b16 v[150:151], v11 offset:512
    v_mfma_f32_32x32x16_bf16 v[224:239], v[136:139], v[84:87], v[224:239]
    s_add_u32 s53, s99, 18432
    buffer_load_dwordx4 v[48:51], v2, s[32:35], s53 offen sc1
    v_mfma_f32_32x32x16_bf16 v[208:223], v[140:143], v[80:83], v[208:223]
    buffer_load_dwordx4 v[52:55], v3, s[32:35], s53 offen sc1
    v_mfma_f32_32x32x16_bf16 v[240:255], v[140:143], v[84:87], v[240:255]
    s_waitcnt lgkmcnt(0)
    v_mfma_f32_32x32x16_bf16 v[192:207], v[144:147], v[88:91], v[192:207]
    ds_read_b64_tr_b16 v[136:137], v10 offset:2048
    ds_read_b64_tr_b16 v[138:139], v10 offset:2560
    ds_read_b64_tr_b16 v[140:141], v11 offset:2048
    ds_read_b64_tr_b16 v[142:143], v11 offset:2560
    v_mfma_f32_32x32x16_bf16 v[224:239], v[144:147], v[92:95], v[224:239]
    s_add_u32 s53, s97, 3072
    buffer_load_dwordx4 v[56:59], v2, s[32:35], s53 offen sc1
    v_mfma_f32_32x32x16_bf16 v[208:223], v[148:151], v[88:91], v[208:223]
    buffer_load_dwordx4 v[60:63], v3, s[32:35], s53 offen sc1
    v_mfma_f32_32x32x16_bf16 v[240:255], v[148:151], v[92:95], v[240:255]
    s_waitcnt vmcnt(14)
    s_waitcnt lgkmcnt(0)
    v_mfma_f32_32x32x16_bf16 v[192:207], v[136:139], v[96:99], v[192:207]
    ds_read_b64_tr_b16 v[144:145], v12 offset:0
    ds_read_b64_tr_b16 v[146:147], v12 offset:512
    ds_read_b64_tr_b16 v[148:149], v13 offset:0
    ds_read_b64_tr_b16 v[150:151], v13 offset:512
    v_mfma_f32_32x32x16_bf16 v[224:239], v[136:139], v[100:103], v[224:239]
    s_add_u32 s53, s97, 7168
    buffer_load_dwordx4 v[64:67], v2, s[32:35], s53 offen sc1
    v_mfma_f32_32x32x16_bf16 v[208:223], v[140:143], v[96:99], v[208:223]
    buffer_load_dwordx4 v[68:71], v3, s[32:35], s53 offen sc1
    v_mfma_f32_32x32x16_bf16 v[240:255], v[140:143], v[100:103], v[240:255]
    s_waitcnt vmcnt(14)
    s_waitcnt lgkmcnt(0)
    v_mfma_f32_32x32x16_bf16 v[192:207], v[144:147], v[104:107], v[192:207]
    ds_read_b64_tr_b16 v[136:137], v12 offset:2048
    ds_read_b64_tr_b16 v[138:139], v12 offset:2560
    ds_read_b64_tr_b16 v[140:141], v13 offset:2048
    ds_read_b64_tr_b16 v[142:143], v13 offset:2560
    v_mfma_f32_32x32x16_bf16 v[224:239], v[144:147], v[108:111], v[224:239]
    s_add_u32 s53, s97, 11264
    buffer_load_dwordx4 v[72:75], v2, s[32:35], s53 offen sc1
    v_mfma_f32_32x32x16_bf16 v[208:223], v[148:151], v[104:107], v[208:223]
    buffer_load_dwordx4 v[76:79], v3, s[32:35], s53 offen sc1
    v_mfma_f32_32x32x16_bf16 v[240:255], v[148:151], v[108:111], v[240:255]
    s_waitcnt vmcnt(14)
    s_waitcnt lgkmcnt(0)
    v_mfma_f32_32x32x16_bf16 v[192:207], v[136:139], v[16:19], v[192:207]
    ds_read_b64_tr_b16 v[144:145], v12 offset:4096
    ds_read_b64_tr_b16 v[146:147], v12 offset:4608
    ds_read_b64_tr_b16 v[148:149], v13 offset:4096
    ds_read_b64_tr_b16 v[150:151], v13 offset:4608
    v_mfma_f32_32x32x16_bf16 v[224:239], v[136:139], v[20:23], v[224:239]
    s_add_u32 s53, s97, 15360
    buffer_load_dwordx4 v[80:83], v2, s[32:35], s53 offen sc1
    v_mfma_f32_32x32x16_bf16 v[208:223], v[140:143], v[16:19], v[208:223]
    buffer_load_dwordx4 v[84:87], v3, s[32:35], s53 offen sc1
    v_mfma_f32_32x32x16_bf16 v[240:255], v[140:143], v[20:23], v[240:255]
    s_waitcnt vmcnt(14)
    s_waitcnt lgkmcnt(0)
    v_mfma_f32_32x32x16_bf16 v[192:207], v[144:147], v[24:27], v[192:207]
    ds_read_b64_tr_b16 v[136:137], v10 offset:4096
    ds_read_b64_tr_b16 v[138:139], v10 offset:4608
    ds_read_b64_tr_b16 v[140:141], v11 offset:4096
    ds_read_b64_tr_b16 v[142:143], v11 offset:4608
    v_mfma_f32_32x32x16_bf16 v[224:239], v[144:147], v[28:31], v[224:239]
    s_add_u32 s53, s97, s43
    s_add_u32 s53, s53, 19456
    buffer_load_dwordx4 v[88:91], v2, s[32:35], s53 offen sc1
    v_mfma_f32_32x32x16_bf16 v[208:223], v[148:151], v[24:27], v[208:223]
    buffer_load_dwordx4 v[92:95], v3, s[32:35], s53 offen sc1
    v_mfma_f32_32x32x16_bf16 v[240:255], v[148:151], v[28:31], v[240:255]
    s_waitcnt vmcnt(14)
    s_waitcnt lgkmcnt(0)
    v_mfma_f32_32x32x16_bf16 v[192:207], v[136:139], v[32:35], v[192:207]
    ds_read_b64_tr_b16 v[144:145], v10 offset:6144
    ds_read_b64_tr_b16 v[146:147], v10 offset:6656
    ds_read_b64_tr_b16 v[148:149], v11 offset:6144
    ds_read_b64_tr_b16 v[150:151], v11 offset:6656
    v_mfma_f32_32x32x16_bf16 v[224:239], v[136:139], v[36:39], v[224:239]
    v_mfma_f32_32x32x16_bf16 v[208:223], v[140:143], v[32:35], v[208:223]
    v_mfma_f32_32x32x16_bf16 v[240:255], v[140:143], v[36:39], v[240:255]
    s_waitcnt vmcnt(12)
    s_waitcnt lgkmcnt(0)
    v_mfma_f32_32x32x16_bf16 v[192:207], v[144:147], v[40:43], v[192:207]
    ds_read_b64_tr_b16 v[136:137], v8 offset:16384
    ds_read_b64_tr_b16 v[138:139], v8 offset:16896
    ds_read_b64_tr_b16 v[140:141], v9 offset:16384
    ds_read_b64_tr_b16 v[142:143], v9 offset:16896
    v_mfma_f32_32x32x16_bf16 v[224:239], v[144:147], v[44:47], v[224:239]
    v_mfma_f32_32x32x16_bf16 v[208:223], v[148:151], v[40:43], v[208:223]
    v_mfma_f32_32x32x16_bf16 v[240:255], v[148:151], v[44:47], v[240:255]
    s_waitcnt vmcnt(10)
    s_waitcnt lgkmcnt(0)
    v_mfma_f32_32x32x16_bf16 v[192:207], v[136:139], v[48:51], v[192:207]
    ds_read_b64_tr_b16 v[144:145], v8 offset:18432
    ds_read_b64_tr_b16 v[146:147], v8 offset:18944
    ds_read_b64_tr_b16 v[148:149], v9 offset:18432
    ds_read_b64_tr_b16 v[150:151], v9 offset:18944
    v_mfma_f32_32x32x16_bf16 v[224:239], v[136:139], v[52:55], v[224:239]
    v_mfma_f32_32x32x16_bf16 v[208:223], v[140:143], v[48:51], v[208:223]
    v_mfma_f32_32x32x16_bf16 v[240:255], v[140:143], v[52:55], v[240:255]
    ds_read_b64_tr_b16 v[152:153], v10 offset:36864
    ds_read_b64_tr_b16 v[154:155], v10 offset:37376
    ds_read_b64_tr_b16 v[156:157], v11 offset:36864
    ds_read_b64_tr_b16 v[158:159], v11 offset:37376
    s_waitcnt vmcnt(8)
    s_waitcnt lgkmcnt(4)
    v_mfma_f32_32x32x16_bf16 v[192:207], v[144:147], v[56:59], v[192:207]
    ds_read_b64_tr_b16 v[136:137], v10 offset:32768
    ds_read_b64_tr_b16 v[138:139], v10 offset:33280
    ds_read_b64_tr_b16 v[140:141], v11 offset:32768
    ds_read_b64_tr_b16 v[142:143], v11 offset:33280
    v_mfma_f32_32x32x16_bf16 v[224:239], v[144:147], v[60:63], v[224:239]
    v_mfma_f32_32x32x16_bf16 v[208:223], v[148:151], v[56:59], v[208:223]
    v_mfma_f32_32x32x16_bf16 v[240:255], v[148:151], v[60:63], v[240:255]
    ds_read_b64_tr_b16 v[160:161], v10 offset:38912
    ds_read_b64_tr_b16 v[162:163], v10 offset:39424
    ds_read_b64_tr_b16 v[164:165], v11 offset:38912
    ds_read_b64_tr_b16 v[166:167], v11 offset:39424
    ds_read_b64_tr_b16 v[144:145], v10 offset:34816
    ds_read_b64_tr_b16 v[146:147], v10 offset:35328
    ds_read_b64_tr_b16 v[148:149], v11 offset:34816
    ds_read_b64_tr_b16 v[150:151], v11 offset:35328
    s_waitcnt vmcnt(0)
    s_waitcnt lgkmcnt(10)
    v_mfma_f32_32x32x16_bf16 v[192:207], v[136:139], v[64:67], v[192:207]
    v_mfma_f32_32x32x16_bf16 v[192:207], v[152:155], v[80:83], v[192:207]
    s_waitcnt lgkmcnt(6)
    v_mfma_f32_32x32x16_bf16 v[192:207], v[160:163], v[88:91], v[192:207]
    s_waitcnt lgkmcnt(2)
    v_mfma_f32_32x32x16_bf16 v[192:207], v[144:147], v[72:75], v[192:207]
    s_waitcnt lgkmcnt(0)
    v_mfma_f32_32x32x16_bf16 v[224:239], v[136:139], v[68:71], v[224:239]
    s_nop 5
    v_mfma_f32_32x32x16_bf16 v[224:239], v[152:155], v[84:87], v[224:239]
    s_nop 3
    ds_write_b128 v7, v[192:195] offset:0
    v_mfma_f32_32x32x16_bf16 v[224:239], v[160:163], v[92:95], v[224:239]
    ds_write_b128 v7, v[196:199] offset:1024
    ds_write_b128 v7, v[200:203] offset:2048
    v_mfma_f32_32x32x16_bf16 v[224:239], v[144:147], v[76:79], v[224:239]
    ds_write_b128 v7, v[204:207] offset:3072
    v_mfma_f32_32x32x16_bf16 v[208:223], v[140:143], v[64:67], v[208:223]
    s_nop 5
    v_mfma_f32_32x32x16_bf16 v[208:223], v[156:159], v[80:83], v[208:223]
    s_nop 3
    ds_write_b128 v7, v[224:227] offset:32768
    v_mfma_f32_32x32x16_bf16 v[208:223], v[164:167], v[88:91], v[208:223]
    ds_write_b128 v7, v[228:231] offset:33792
    ds_write_b128 v7, v[232:235] offset:34816
    v_mfma_f32_32x32x16_bf16 v[208:223], v[148:151], v[72:75], v[208:223]
    ds_write_b128 v7, v[236:239] offset:35840
    v_mfma_f32_32x32x16_bf16 v[240:255], v[140:143], v[68:71], v[240:255]
    s_nop 5
    v_mfma_f32_32x32x16_bf16 v[240:255], v[156:159], v[84:87], v[240:255]
    s_nop 3
    ds_write_b128 v7, v[208:211] offset:4096
    v_mfma_f32_32x32x16_bf16 v[240:255], v[164:167], v[92:95], v[240:255]
    ds_write_b128 v7, v[212:215] offset:5120
    ds_write_b128 v7, v[216:219] offset:6144
    v_mfma_f32_32x32x16_bf16 v[240:255], v[148:151], v[76:79], v[240:255]
    ds_write_b128 v7, v[220:223] offset:7168
    s_nop 7
    s_nop 3
    ds_write_b128 v7, v[240:243] offset:36864
    ds_write_b128 v7, v[244:247] offset:37888
    ds_write_b128 v7, v[248:251] offset:38912
    ds_write_b128 v7, v[252:255] offset:39936
    s_waitcnt lgkmcnt(0)
    s_barrier
    s_endpgm
L_NS0:
    s_mov_b32 s56, 0
L_NT0:
    buffer_load_dword v131, v128, s[32:35], s55 offen sc1
    s_add_u32 s56, s56, 1
    s_add_u32 s57, s57, 1
    s_waitcnt vmcnt(0)
    v_cmp_eq_u32 vcc, s92, v131
    s_cmp_ge_u32 s56, 32768
    s_cbranch_scc1 L_NR0
    s_nop 1
    s_or_b32 s47, s47, vcc_lo
    s_and_b32 s53, s47, 1023
    s_cmp_eq_u32 s53, 1023
    s_cbranch_scc1 L_NR0
    s_sleep 1
    s_branch L_NT0
L_NS10:
    s_mov_b32 s56, 0
L_NT10:
    buffer_load_dword v131, v128, s[32:35], s55 offen sc1
    s_add_u32 s56, s56, 1
    s_add_u32 s57, s57, 1
    s_waitcnt vmcnt(0)
    v_cmp_eq_u32 vcc, s92, v131
    s_cmp_ge_u32 s56, 32768
    s_cbranch_scc1 L_NR10
    s_nop 1
    s_or_b32 s47, s47, vcc_lo
    s_and_b32 s53, s47, 4194303
    s_cmp_eq_u32 s53, 4194303
    s_cbranch_scc1 L_NR10
    s_sleep 1
    s_branch L_NT10
L_CS:
    v_lshrrev_b32 v2, 4, v0
    v_and_b32 v3, 15, v0
    v_mul_u32_u24 v2, 2752, v2
    v_lshl_add_u32 v2, v3, 4, v2
    s_lshl_b32 s38, s23, 8
    s_lshr_b32 s39, s20, 1
    s_mul_i32 s39, s39, 352256
    s_add_u32 s38, s38, s39
    s_and_b32 s39, s20, 1
    s_cmp_eq_u32 s39, 0
    s_waitcnt lgkmcnt(0)
    s_cselect_b32 s28, s12, s14
    s_cselect_b32 s29, s13, s15
    s_mov_b32 s30, 1409024
    s_mov_b32 s31, 0x00020000
    s_mov_b32 s24, s4
    s_mov_b32 s25, s5
    s_mov_b32 s26, 2097152
    s_mov_b32 s27, 0x00020000
    s_mov_b32 s32, s16
    s_mov_b32 s33, s17
    s_mov_b32 s34, 10485760
    s_mov_b32 s35, 0x00020000
    s_mov_b32 s88, s80
    s_mov_b32 s89, s81
    s_mov_b32 s90, 256
    s_mov_b32 s91, 0x00020000
    s_sub_u32 s36, s20, 4
    v_mov_b32 v146, 0
    buffer_load_dwordx2 v[144:145], v146, s[88:91], 0 offen sc1
    buffer_load_dwordx4 v[16:19], v2, s[28:31], s38 offen
    s_add_u32 s38, s38, 11008
    buffer_load_dwordx4 v[20:23], v2, s[28:31], s38 offen
    s_add_u32 s38, s38, 11008
    buffer_load_dwordx4 v[24:27], v2, s[28:31], s38 offen
    s_add_u32 s38, s38, 11008
    buffer_load_dwordx4 v[28:31], v2, s[28:31], s38 offen
    s_add_u32 s38, s38, 11008
    buffer_load_dwordx4 v[32:35], v2, s[28:31], s38 offen
    s_add_u32 s38, s38, 11008
    buffer_load_dwordx4 v[36:39], v2, s[28:31], s38 offen
    s_add_u32 s38, s38, 11008
    buffer_load_dwordx4 v[40:43], v2, s[28:31], s38 offen
    s_add_u32 s38, s38, 11008
    buffer_load_dwordx4 v[44:47], v2, s[28:31], s38 offen
    s_add_u32 s38, s38, 11008
    buffer_load_dwordx4 v[48:51], v2, s[28:31], s38 offen
    s_add_u32 s38, s38, 11008
    buffer_load_dwordx4 v[52:55], v2, s[28:31], s38 offen
    s_add_u32 s38, s38, 11008
    buffer_load_dwordx4 v[56:59], v2, s[28:31], s38 offen
    s_add_u32 s38, s38, 11008
    buffer_load_dwordx4 v[60:63], v2, s[28:31], s38 offen
    s_add_u32 s38, s38, 11008
    buffer_load_dwordx4 v[64:67], v2, s[28:31], s38 offen
    s_add_u32 s38, s38, 11008
    buffer_load_dwordx4 v[68:71], v2, s[28:31], s38 offen
    s_add_u32 s38, s38, 11008
    buffer_load_dwordx4 v[72:75], v2, s[28:31], s38 offen
    s_add_u32 s38, s38, 11008
    buffer_load_dwordx4 v[76:79], v2, s[28:31], s38 offen
    s_add_u32 s38, s38, 11008
    buffer_load_dwordx4 v[80:83], v2, s[28:31], s38 offen
    s_add_u32 s38, s38, 11008
    buffer_load_dwordx4 v[84:87], v2, s[28:31], s38 offen
    s_add_u32 s38, s38, 11008
    buffer_load_dwordx4 v[88:91], v2, s[28:31], s38 offen
    s_add_u32 s38, s38, 11008
    buffer_load_dwordx4 v[92:95], v2, s[28:31], s38 offen
    s_add_u32 s38, s38, 11008
    buffer_load_dwordx4 v[96:99], v2, s[28:31], s38 offen
    s_add_u32 s38, s38, 11008
    buffer_load_dwordx4 v[100:103], v2, s[28:31], s38 offen
    s_add_u32 s38, s38, 11008
    buffer_load_dwordx4 v[104:107], v2, s[28:31], s38 offen
    s_add_u32 s38, s38, 11008
    buffer_load_dwordx4 v[108:111], v2, s[28:31], s38 offen
    s_add_u32 s38, s38, 11008
    buffer_load_dwordx4 v[112:115], v2, s[28:31], s38 offen
    s_add_u32 s38, s38, 11008
    buffer_load_dwordx4 v[116:119], v2, s[28:31], s38 offen
    s_add_u32 s38, s38, 11008
    buffer_load_dwordx4 v[120:123], v2, s[28:31], s38 offen
    s_add_u32 s38, s38, 11008
    buffer_load_dwordx4 v[124:127], v2, s[28:31], s38 offen
    s_add_u32 s38, s38, 11008
    buffer_load_dwordx4 v[128:131], v2, s[28:31], s38 offen
    s_add_u32 s38, s38, 11008
    buffer_load_dwordx4 v[132:135], v2, s[28:31], s38 offen
    s_add_u32 s38, s38, 11008
    buffer_load_dwordx4 v[136:139], v2, s[28:31], s38 offen
    s_add_u32 s38, s38, 11008
    buffer_load_dwordx4 v[140:143], v2, s[28:31], s38 offen
    s_add_u32 s38, s38, 11008
    s_mov_b32 s48, 0xffff0000
    v_mov_b32 v8, 0
    v_mov_b32 v9, 0
    v_mov_b32 v10, 0
    v_mov_b32 v11, 0
    v_mov_b32 v12, 0
    v_mov_b32 v13, 0
    v_mov_b32 v14, 0
    v_mov_b32 v15, 0
    s_waitcnt vmcnt(28)
    v_readfirstlane_b32 s92, v144
    v_readfirstlane_b32 s93, v145
    s_mov_b32 s56, 0
    s_cmp_ge_u32 s56, 32768
    s_cbranch_scc1 L_CS_N1
    s_cmp_eq_u32 s92, 0
    s_cbranch_scc1 L_CS_N2
    s_memrealtime s[40:41]
    s_waitcnt lgkmcnt(0)
    s_sub_u32 s41, s40, s92
    s_cmp_lt_i32 s41, 800
    s_cbranch_scc1 L_CS_N1
    s_cmp_ge_u32 s56, 40
    s_cbranch_scc1 L_CS_N1
L_CS_N2:
    v_mov_b32 v146, 0
    s_mov_b32 s56, 0
L_CS_N0:
    buffer_load_dwordx2 v[144:145], v146, s[88:91], 0 offen sc1
    s_add_u32 s56, s56, 1
    s_waitcnt vmcnt(0)
    v_readfirstlane_b32 s92, v144
    v_readfirstlane_b32 s93, v145
    s_nop 1
    s_cmp_ge_u32 s56, 32768
    s_cbranch_scc1 L_CS_N0_OK
    s_cmp_eq_u32 s92, 0
    s_cbranch_scc1 L_CS_N0
    s_memrealtime s[40:41]
    s_waitcnt lgkmcnt(0)
    s_sub_u32 s41, s40, s92
    s_cmp_lt_i32 s41, 800
    s_cbranch_scc1 L_CS_N0_OK
    s_cmp_ge_u32 s56, 40
    s_cbranch_scc1 L_CS_N0_OK
    s_branch L_CS_N0
L_CS_N0_OK:
L_CS_N1:
    s_getreg_b32 s100, hwreg(HW_REG_XCC_ID, 0, 4)
    s_lshl_b32 s53, s2, 7
    s_add_u32 s53, s53, 9502720
    s_cmp_eq_u32 s36, 0
    s_cselect_b32 s53, s53, 2130706432
    v_mov_b32 v144, s100
    v_mov_b32 v145, s92
    v_mov_b32 v146, 0
    s_mov_b64 exec, 1
    buffer_store_dwordx2 v[144:145], v146, s[32:35], s53 offen sc1
    s_mov_b64 exec, -1
    v_lshlrev_b32 v4, 16, v16
    v_and_b32 v5, s48, v16
    v_add_f32 v8, v8, v4
    v_add_f32 v9, v9, v5
    v_lshlrev_b32 v4, 16, v17
    v_and_b32 v5, s48, v17
    v_add_f32 v10, v10, v4
    v_add_f32 v11, v11, v5
    v_lshlrev_b32 v4, 16, v18
    v_and_b32 v5, s48, v18
    v_add_f32 v12, v12, v4
    v_add_f32 v13, v13, v5
    v_lshlrev_b32 v4, 16, v19
    v_and_b32 v5, s48, v19
    v_add_f32 v14, v14, v4
    v_add_f32 v15, v15, v5
    v_lshlrev_b32 v4, 16, v20
    v_and_b32 v5, s48, v20
    v_add_f32 v8, v8, v4
    v_add_f32 v9, v9, v5
    v_lshlrev_b32 v4, 16, v21
    v_and_b32 v5, s48, v21
    v_add_f32 v10, v10, v4
    v_add_f32 v11, v11, v5
    v_lshlrev_b32 v4, 16, v22
    v_and_b32 v5, s48, v22
    v_add_f32 v12, v12, v4
    v_add_f32 v13, v13, v5
    v_lshlrev_b32 v4, 16, v23
    v_and_b32 v5, s48, v23
    v_add_f32 v14, v14, v4
    v_add_f32 v15, v15, v5
    v_lshlrev_b32 v4, 16, v24
    v_and_b32 v5, s48, v24
    v_add_f32 v8, v8, v4
    v_add_f32 v9, v9, v5
    v_lshlrev_b32 v4, 16, v25
    v_and_b32 v5, s48, v25
    v_add_f32 v10, v10, v4
    v_add_f32 v11, v11, v5
    v_lshlrev_b32 v4, 16, v26
    v_and_b32 v5, s48, v26
    v_add_f32 v12, v12, v4
    v_add_f32 v13, v13, v5
    v_lshlrev_b32 v4, 16, v27
    v_and_b32 v5, s48, v27
    v_add_f32 v14, v14, v4
    v_add_f32 v15, v15, v5
    v_lshlrev_b32 v4, 16, v28
    v_and_b32 v5, s48, v28
    v_add_f32 v8, v8, v4
    v_add_f32 v9, v9, v5
    v_lshlrev_b32 v4, 16, v29
    v_and_b32 v5, s48, v29
    v_add_f32 v10, v10, v4
    v_add_f32 v11, v11, v5
    v_lshlrev_b32 v4, 16, v30
    v_and_b32 v5, s48, v30
    v_add_f32 v12, v12, v4
    v_add_f32 v13, v13, v5
    v_lshlrev_b32 v4, 16, v31
    v_and_b32 v5, s48, v31
    v_add_f32 v14, v14, v4
    v_add_f32 v15, v15, v5
    s_waitcnt vmcnt(24)
    v_lshlrev_b32 v4, 16, v32
    v_and_b32 v5, s48, v32
    v_add_f32 v8, v8, v4
    v_add_f32 v9, v9, v5
    v_lshlrev_b32 v4, 16, v33
    v_and_b32 v5, s48, v33
    v_add_f32 v10, v10, v4
    v_add_f32 v11, v11, v5
    v_lshlrev_b32 v4, 16, v34
    v_and_b32 v5, s48, v34
    v_add_f32 v12, v12, v4
    v_add_f32 v13, v13, v5
    v_lshlrev_b32 v4, 16, v35
    v_and_b32 v5, s48, v35
    v_add_f32 v14, v14, v4
    v_add_f32 v15, v15, v5
    v_lshlrev_b32 v4, 16, v36
    v_and_b32 v5, s48, v36
    v_add_f32 v8, v8, v4
    v_add_f32 v9, v9, v5
    v_lshlrev_b32 v4, 16, v37
    v_and_b32 v5, s48, v37
    v_add_f32 v10, v10, v4
    v_add_f32 v11, v11, v5
    v_lshlrev_b32 v4, 16, v38
    v_and_b32 v5, s48, v38
    v_add_f32 v12, v12, v4
    v_add_f32 v13, v13, v5
    v_lshlrev_b32 v4, 16, v39
    v_and_b32 v5, s48, v39
    v_add_f32 v14, v14, v4
    v_add_f32 v15, v15, v5
    v_lshlrev_b32 v4, 16, v40
    v_and_b32 v5, s48, v40
    v_add_f32 v8, v8, v4
    v_add_f32 v9, v9, v5
    v_lshlrev_b32 v4, 16, v41
    v_and_b32 v5, s48, v41
    v_add_f32 v10, v10, v4
    v_add_f32 v11, v11, v5
    v_lshlrev_b32 v4, 16, v42
    v_and_b32 v5, s48, v42
    v_add_f32 v12, v12, v4
    v_add_f32 v13, v13, v5
    v_lshlrev_b32 v4, 16, v43
    v_and_b32 v5, s48, v43
    v_add_f32 v14, v14, v4
    v_add_f32 v15, v15, v5
    v_lshlrev_b32 v4, 16, v44
    v_and_b32 v5, s48, v44
    v_add_f32 v8, v8, v4
    v_add_f32 v9, v9, v5
    v_lshlrev_b32 v4, 16, v45
    v_and_b32 v5, s48, v45
    v_add_f32 v10, v10, v4
    v_add_f32 v11, v11, v5
    v_lshlrev_b32 v4, 16, v46
    v_and_b32 v5, s48, v46
    v_add_f32 v12, v12, v4
    v_add_f32 v13, v13, v5
    v_lshlrev_b32 v4, 16, v47
    v_and_b32 v5, s48, v47
    v_add_f32 v14, v14, v4
    v_add_f32 v15, v15, v5
    s_waitcnt vmcnt(20)
    v_lshlrev_b32 v4, 16, v48
    v_and_b32 v5, s48, v48
    v_add_f32 v8, v8, v4
    v_add_f32 v9, v9, v5
    v_lshlrev_b32 v4, 16, v49
    v_and_b32 v5, s48, v49
    v_add_f32 v10, v10, v4
    v_add_f32 v11, v11, v5
    v_lshlrev_b32 v4, 16, v50
    v_and_b32 v5, s48, v50
    v_add_f32 v12, v12, v4
    v_add_f32 v13, v13, v5
    v_lshlrev_b32 v4, 16, v51
    v_and_b32 v5, s48, v51
    v_add_f32 v14, v14, v4
    v_add_f32 v15, v15, v5
    v_lshlrev_b32 v4, 16, v52
    v_and_b32 v5, s48, v52
    v_add_f32 v8, v8, v4
    v_add_f32 v9, v9, v5
    v_lshlrev_b32 v4, 16, v53
    v_and_b32 v5, s48, v53
    v_add_f32 v10, v10, v4
    v_add_f32 v11, v11, v5
    v_lshlrev_b32 v4, 16, v54
    v_and_b32 v5, s48, v54
    v_add_f32 v12, v12, v4
    v_add_f32 v13, v13, v5
    v_lshlrev_b32 v4, 16, v55
    v_and_b32 v5, s48, v55
    v_add_f32 v14, v14, v4
    v_add_f32 v15, v15, v5
    v_lshlrev_b32 v4, 16, v56
    v_and_b32 v5, s48, v56
    v_add_f32 v8, v8, v4
    v_add_f32 v9, v9, v5
    v_lshlrev_b32 v4, 16, v57
    v_and_b32 v5, s48, v57
    v_add_f32 v10, v10, v4
    v_add_f32 v11, v11, v5
    v_lshlrev_b32 v4, 16, v58
    v_and_b32 v5, s48, v58
    v_add_f32 v12, v12, v4
    v_add_f32 v13, v13, v5
    v_lshlrev_b32 v4, 16, v59
    v_and_b32 v5, s48, v59
    v_add_f32 v14, v14, v4
    v_add_f32 v15, v15, v5
    v_lshlrev_b32 v4, 16, v60
    v_and_b32 v5, s48, v60
    v_add_f32 v8, v8, v4
    v_add_f32 v9, v9, v5
    v_lshlrev_b32 v4, 16, v61
    v_and_b32 v5, s48, v61
    v_add_f32 v10, v10, v4
    v_add_f32 v11, v11, v5
    v_lshlrev_b32 v4, 16, v62
    v_and_b32 v5, s48, v62
    v_add_f32 v12, v12, v4
    v_add_f32 v13, v13, v5
    v_lshlrev_b32 v4, 16, v63
    v_and_b32 v5, s48, v63
    v_add_f32 v14, v14, v4
    v_add_f32 v15, v15, v5
    s_waitcnt vmcnt(16)
    v_lshlrev_b32 v4, 16, v64
    v_and_b32 v5, s48, v64
    v_add_f32 v8, v8, v4
    v_add_f32 v9, v9, v5
    v_lshlrev_b32 v4, 16, v65
    v_and_b32 v5, s48, v65
    v_add_f32 v10, v10, v4
    v_add_f32 v11, v11, v5
    v_lshlrev_b32 v4, 16, v66
    v_and_b32 v5, s48, v66
    v_add_f32 v12, v12, v4
    v_add_f32 v13, v13, v5
    v_lshlrev_b32 v4, 16, v67
    v_and_b32 v5, s48, v67
    v_add_f32 v14, v14, v4
    v_add_f32 v15, v15, v5
    v_lshlrev_b32 v4, 16, v68
    v_and_b32 v5, s48, v68
    v_add_f32 v8, v8, v4
    v_add_f32 v9, v9, v5
    v_lshlrev_b32 v4, 16, v69
    v_and_b32 v5, s48, v69
    v_add_f32 v10, v10, v4
    v_add_f32 v11, v11, v5
    v_lshlrev_b32 v4, 16, v70
    v_and_b32 v5, s48, v70
    v_add_f32 v12, v12, v4
    v_add_f32 v13, v13, v5
    v_lshlrev_b32 v4, 16, v71
    v_and_b32 v5, s48, v71
    v_add_f32 v14, v14, v4
    v_add_f32 v15, v15, v5
    v_lshlrev_b32 v4, 16, v72
    v_and_b32 v5, s48, v72
    v_add_f32 v8, v8, v4
    v_add_f32 v9, v9, v5
    v_lshlrev_b32 v4, 16, v73
    v_and_b32 v5, s48, v73
    v_add_f32 v10, v10, v4
    v_add_f32 v11, v11, v5
    v_lshlrev_b32 v4, 16, v74
    v_and_b32 v5, s48, v74
    v_add_f32 v12, v12, v4
    v_add_f32 v13, v13, v5
    v_lshlrev_b32 v4, 16, v75
    v_and_b32 v5, s48, v75
    v_add_f32 v14, v14, v4
    v_add_f32 v15, v15, v5
    v_lshlrev_b32 v4, 16, v76
    v_and_b32 v5, s48, v76
    v_add_f32 v8, v8, v4
    v_add_f32 v9, v9, v5
    v_lshlrev_b32 v4, 16, v77
    v_and_b32 v5, s48, v77
    v_add_f32 v10, v10, v4
    v_add_f32 v11, v11, v5
    v_lshlrev_b32 v4, 16, v78
    v_and_b32 v5, s48, v78
    v_add_f32 v12, v12, v4
    v_add_f32 v13, v13, v5
    v_lshlrev_b32 v4, 16, v79
    v_and_b32 v5, s48, v79
    v_add_f32 v14, v14, v4
    v_add_f32 v15, v15, v5
    s_waitcnt vmcnt(12)
    v_lshlrev_b32 v4, 16, v80
    v_and_b32 v5, s48, v80
    v_add_f32 v8, v8, v4
    v_add_f32 v9, v9, v5
    v_lshlrev_b32 v4, 16, v81
    v_and_b32 v5, s48, v81
    v_add_f32 v10, v10, v4
    v_add_f32 v11, v11, v5
    v_lshlrev_b32 v4, 16, v82
    v_and_b32 v5, s48, v82
    v_add_f32 v12, v12, v4
    v_add_f32 v13, v13, v5
    v_lshlrev_b32 v4, 16, v83
    v_and_b32 v5, s48, v83
    v_add_f32 v14, v14, v4
    v_add_f32 v15, v15, v5
    v_lshlrev_b32 v4, 16, v84
    v_and_b32 v5, s48, v84
    v_add_f32 v8, v8, v4
    v_add_f32 v9, v9, v5
    v_lshlrev_b32 v4, 16, v85
    v_and_b32 v5, s48, v85
    v_add_f32 v10, v10, v4
    v_add_f32 v11, v11, v5
    v_lshlrev_b32 v4, 16, v86
    v_and_b32 v5, s48, v86
    v_add_f32 v12, v12, v4
    v_add_f32 v13, v13, v5
    v_lshlrev_b32 v4, 16, v87
    v_and_b32 v5, s48, v87
    v_add_f32 v14, v14, v4
    v_add_f32 v15, v15, v5
    v_lshlrev_b32 v4, 16, v88
    v_and_b32 v5, s48, v88
    v_add_f32 v8, v8, v4
    v_add_f32 v9, v9, v5
    v_lshlrev_b32 v4, 16, v89
    v_and_b32 v5, s48, v89
    v_add_f32 v10, v10, v4
    v_add_f32 v11, v11, v5
    v_lshlrev_b32 v4, 16, v90
    v_and_b32 v5, s48, v90
    v_add_f32 v12, v12, v4
    v_add_f32 v13, v13, v5
    v_lshlrev_b32 v4, 16, v91
    v_and_b32 v5, s48, v91
    v_add_f32 v14, v14, v4
    v_add_f32 v15, v15, v5
    v_lshlrev_b32 v4, 16, v92
    v_and_b32 v5, s48, v92
    v_add_f32 v8, v8, v4
    v_add_f32 v9, v9, v5
    v_lshlrev_b32 v4, 16, v93
    v_and_b32 v5, s48, v93
    v_add_f32 v10, v10, v4
    v_add_f32 v11, v11, v5
    v_lshlrev_b32 v4, 16, v94
    v_and_b32 v5, s48, v94
    v_add_f32 v12, v12, v4
    v_add_f32 v13, v13, v5
    v_lshlrev_b32 v4, 16, v95
    v_and_b32 v5, s48, v95
    v_add_f32 v14, v14, v4
    v_add_f32 v15, v15, v5
    s_waitcnt vmcnt(8)
    v_lshlrev_b32 v4, 16, v96
    v_and_b32 v5, s48, v96
    v_add_f32 v8, v8, v4
    v_add_f32 v9, v9, v5
    v_lshlrev_b32 v4, 16, v97
    v_and_b32 v5, s48, v97
    v_add_f32 v10, v10, v4
    v_add_f32 v11, v11, v5
    v_lshlrev_b32 v4, 16, v98
    v_and_b32 v5, s48, v98
    v_add_f32 v12, v12, v4
    v_add_f32 v13, v13, v5
    v_lshlrev_b32 v4, 16, v99
    v_and_b32 v5, s48, v99
    v_add_f32 v14, v14, v4
    v_add_f32 v15, v15, v5
    v_lshlrev_b32 v4, 16, v100
    v_and_b32 v5, s48, v100
    v_add_f32 v8, v8, v4
    v_add_f32 v9, v9, v5
    v_lshlrev_b32 v4, 16, v101
    v_and_b32 v5, s48, v101
    v_add_f32 v10, v10, v4
    v_add_f32 v11, v11, v5
    v_lshlrev_b32 v4, 16, v102
    v_and_b32 v5, s48, v102
    v_add_f32 v12, v12, v4
    v_add_f32 v13, v13, v5
    v_lshlrev_b32 v4, 16, v103
    v_and_b32 v5, s48, v103
    v_add_f32 v14, v14, v4
    v_add_f32 v15, v15, v5
    v_lshlrev_b32 v4, 16, v104
    v_and_b32 v5, s48, v104
    v_add_f32 v8, v8, v4
    v_add_f32 v9, v9, v5
    v_lshlrev_b32 v4, 16, v105
    v_and_b32 v5, s48, v105
    v_add_f32 v10, v10, v4
    v_add_f32 v11, v11, v5
    v_lshlrev_b32 v4, 16, v106
    v_and_b32 v5, s48, v106
    v_add_f32 v12, v12, v4
    v_add_f32 v13, v13, v5
    v_lshlrev_b32 v4, 16, v107
    v_and_b32 v5, s48, v107
    v_add_f32 v14, v14, v4
    v_add_f32 v15, v15, v5
    v_lshlrev_b32 v4, 16, v108
    v_and_b32 v5, s48, v108
    v_add_f32 v8, v8, v4
    v_add_f32 v9, v9, v5
    v_lshlrev_b32 v4, 16, v109
    v_and_b32 v5, s48, v109
    v_add_f32 v10, v10, v4
    v_add_f32 v11, v11, v5
    v_lshlrev_b32 v4, 16, v110
    v_and_b32 v5, s48, v110
    v_add_f32 v12, v12, v4
    v_add_f32 v13, v13, v5
    v_lshlrev_b32 v4, 16, v111
    v_and_b32 v5, s48, v111
    v_add_f32 v14, v14, v4
    v_add_f32 v15, v15, v5
    s_waitcnt vmcnt(4)
    v_lshlrev_b32 v4, 16, v112
    v_and_b32 v5, s48, v112
    v_add_f32 v8, v8, v4
    v_add_f32 v9, v9, v5
    v_lshlrev_b32 v4, 16, v113
    v_and_b32 v5, s48, v113
    v_add_f32 v10, v10, v4
    v_add_f32 v11, v11, v5
    v_lshlrev_b32 v4, 16, v114
    v_and_b32 v5, s48, v114
    v_add_f32 v12, v12, v4
    v_add_f32 v13, v13, v5
    v_lshlrev_b32 v4, 16, v115
    v_and_b32 v5, s48, v115
    v_add_f32 v14, v14, v4
    v_add_f32 v15, v15, v5
    v_lshlrev_b32 v4, 16, v116
    v_and_b32 v5, s48, v116
    v_add_f32 v8, v8, v4
    v_add_f32 v9, v9, v5
    v_lshlrev_b32 v4, 16, v117
    v_and_b32 v5, s48, v117
    v_add_f32 v10, v10, v4
    v_add_f32 v11, v11, v5
    v_lshlrev_b32 v4, 16, v118
    v_and_b32 v5, s48, v118
    v_add_f32 v12, v12, v4
    v_add_f32 v13, v13, v5
    v_lshlrev_b32 v4, 16, v119
    v_and_b32 v5, s48, v119
    v_add_f32 v14, v14, v4
    v_add_f32 v15, v15, v5
    v_lshlrev_b32 v4, 16, v120
    v_and_b32 v5, s48, v120
    v_add_f32 v8, v8, v4
    v_add_f32 v9, v9, v5
    v_lshlrev_b32 v4, 16, v121
    v_and_b32 v5, s48, v121
    v_add_f32 v10, v10, v4
    v_add_f32 v11, v11, v5
    v_lshlrev_b32 v4, 16, v122
    v_and_b32 v5, s48, v122
    v_add_f32 v12, v12, v4
    v_add_f32 v13, v13, v5
    v_lshlrev_b32 v4, 16, v123
    v_and_b32 v5, s48, v123
    v_add_f32 v14, v14, v4
    v_add_f32 v15, v15, v5
    v_lshlrev_b32 v4, 16, v124
    v_and_b32 v5, s48, v124
    v_add_f32 v8, v8, v4
    v_add_f32 v9, v9, v5
    v_lshlrev_b32 v4, 16, v125
    v_and_b32 v5, s48, v125
    v_add_f32 v10, v10, v4
    v_add_f32 v11, v11, v5
    v_lshlrev_b32 v4, 16, v126
    v_and_b32 v5, s48, v126
    v_add_f32 v12, v12, v4
    v_add_f32 v13, v13, v5
    v_lshlrev_b32 v4, 16, v127
    v_and_b32 v5, s48, v127
    v_add_f32 v14, v14, v4
    v_add_f32 v15, v15, v5
    s_waitcnt vmcnt(0)
    v_lshlrev_b32 v4, 16, v128
    v_and_b32 v5, s48, v128
    v_add_f32 v8, v8, v4
    v_add_f32 v9, v9, v5
    v_lshlrev_b32 v4, 16, v129
    v_and_b32 v5, s48, v129
    v_add_f32 v10, v10, v4
    v_add_f32 v11, v11, v5
    v_lshlrev_b32 v4, 16, v130
    v_and_b32 v5, s48, v130
    v_add_f32 v12, v12, v4
    v_add_f32 v13, v13, v5
    v_lshlrev_b32 v4, 16, v131
    v_and_b32 v5, s48, v131
    v_add_f32 v14, v14, v4
    v_add_f32 v15, v15, v5
    v_lshlrev_b32 v4, 16, v132
    v_and_b32 v5, s48, v132
    v_add_f32 v8, v8, v4
    v_add_f32 v9, v9, v5
    v_lshlrev_b32 v4, 16, v133
    v_and_b32 v5, s48, v133
    v_add_f32 v10, v10, v4
    v_add_f32 v11, v11, v5
    v_lshlrev_b32 v4, 16, v134
    v_and_b32 v5, s48, v134
    v_add_f32 v12, v12, v4
    v_add_f32 v13, v13, v5
    v_lshlrev_b32 v4, 16, v135
    v_and_b32 v5, s48, v135
    v_add_f32 v14, v14, v4
    v_add_f32 v15, v15, v5
    v_lshlrev_b32 v4, 16, v136
    v_and_b32 v5, s48, v136
    v_add_f32 v8, v8, v4
    v_add_f32 v9, v9, v5
    v_lshlrev_b32 v4, 16, v137
    v_and_b32 v5, s48, v137
    v_add_f32 v10, v10, v4
    v_add_f32 v11, v11, v5
    v_lshlrev_b32 v4, 16, v138
    v_and_b32 v5, s48, v138
    v_add_f32 v12, v12, v4
    v_add_f32 v13, v13, v5
    v_lshlrev_b32 v4, 16, v139
    v_and_b32 v5, s48, v139
    v_add_f32 v14, v14, v4
    v_add_f32 v15, v15, v5
    v_lshlrev_b32 v4, 16, v140
    v_and_b32 v5, s48, v140
    v_add_f32 v8, v8, v4
    v_add_f32 v9, v9, v5
    v_lshlrev_b32 v4, 16, v141
    v_and_b32 v5, s48, v141
    v_add_f32 v10, v10, v4
    v_add_f32 v11, v11, v5
    v_lshlrev_b32 v4, 16, v142
    v_and_b32 v5, s48, v142
    v_add_f32 v12, v12, v4
    v_add_f32 v13, v13, v5
    v_lshlrev_b32 v4, 16, v143
    v_and_b32 v5, s48, v143
    v_add_f32 v14, v14, v4
    v_add_f32 v15, v15, v5
    s_lshl_b32 s38, s20, 11
    v_lshlrev_b32 v2, 5, v0
    v_add_u32 v2, s38, v2
    ds_write_b128 v2, v[8:11]
    ds_write_b128 v2, v[12:15] offset:16
    s_waitcnt lgkmcnt(0)
    s_barrier
    s_cmp_lt_u32 s20, 4
    s_cbranch_scc0 L_CS_H
    s_lshr_b32 s38, s20, 1
    s_lshl_b32 s38, s38, 11
    s_and_b32 s39, s20, 1
    s_lshl_b32 s39, s39, 8
    s_add_u32 s38, s38, s39
    v_lshlrev_b32 v2, 2, v0
    v_add_u32 v2, s38, v2
    ds_read_b32 v16, v2 offset:0
    ds_read_b32 v17, v2 offset:512
    ds_read_b32 v18, v2 offset:1024
    ds_read_b32 v19, v2 offset:1536
    ds_read_b32 v20, v2 offset:4096
    ds_read_b32 v21, v2 offset:4608
    ds_read_b32 v22, v2 offset:5120
    ds_read_b32 v23, v2 offset:5632
    s_waitcnt lgkmcnt(0)
    ds_read_b32 v24, v2 offset:8192
    ds_read_b32 v25, v2 offset:8704
    ds_read_b32 v26, v2 offset:9216
    ds_read_b32 v27, v2 offset:9728
    ds_read_b32 v28, v2 offset:12288
    ds_read_b32 v29, v2 offset:12800
    ds_read_b32 v30, v2 offset:13312
    ds_read_b32 v31, v2 offset:13824
    s_waitcnt lgkmcnt(0)
    s_barrier
    v_add_f32 v16, v16, v17
    v_add_f32 v16, v16, v18
    v_add_f32 v16, v16, v19
    v_add_f32 v16, v16, v20
    v_add_f32 v16, v16, v21
    v_add_f32 v16, v16, v22
    v_add_f32 v16, v16, v23
    v_add_f32 v16, v16, v24
    v_add_f32 v16, v16, v25
    v_add_f32 v16, v16, v26
    v_add_f32 v16, v16, v27
    v_add_f32 v16, v16, v28
    v_add_f32 v16, v16, v29
    v_add_f32 v16, v16, v30
    v_add_f32 v16, v16, v31
    v_mov_b32 v17, s92
    s_lshl_b32 s38, s23, 11
    s_lshl_b32 s39, s20, 9
    s_add_u32 s38, s38, s39
    s_add_u32 s38, s38, 9478144
    v_lshlrev_b32 v2, 3, v0
    buffer_store_dwordx2 v[16:17], v2, s[32:35], s38 offen sc1
    s_branch L_FIN
L_CS_H:
    s_barrier
    s_sub_u32 s36, s20, 4
    s_branch L_HI
L_MMA:
    s_lshr_b32 s36, s20, 1
    s_and_b32 s37, s20, 1
    s_waitcnt lgkmcnt(0)
    s_mov_b32 s24, s4
    s_mov_b32 s25, s5
    s_mov_b32 s26, 2097152
    s_mov_b32 s27, 0x00020000
    s_mov_b32 s32, s16
    s_mov_b32 s33, s17
    s_mov_b32 s34, 10485760
    s_mov_b32 s35, 0x00020000
    s_mov_b32 s88, s80
    s_mov_b32 s89, s81
    s_mov_b32 s90, 256
    s_mov_b32 s91, 0x00020000
    s_cmp_eq_u32 s21, 2
    s_cbranch_scc0 L_MMA2
    v_mov_b32 v6, 0
    s_mov_b32 s56, 0
L_MI_N:
    buffer_load_dwordx2 v[4:5], v6, s[88:91], 0 offen sc1
    s_add_u32 s56, s56, 1
    s_waitcnt vmcnt(0)
    v_readfirstlane_b32 s92, v4
    v_readfirstlane_b32 s93, v5
    s_nop 1
    s_cmp_ge_u32 s56, 32768
    s_cbranch_scc1 L_MI_N_OK
    s_cmp_eq_u32 s92, 0
    s_cbranch_scc1 L_MI_N
    s_memrealtime s[40:41]
    s_waitcnt lgkmcnt(0)
    s_sub_u32 s41, s40, s92
    s_cmp_lt_i32 s41, 800
    s_cbranch_scc1 L_MI_N_OK
    s_cmp_ge_u32 s56, 40
    s_cbranch_scc1 L_MI_N_OK
    s_branch L_MI_N
L_MI_N_OK:
    s_branch L_FIN
L_MMA2:
    s_cmp_lt_u32 s20, 2
    s_cbranch_scc0 L_WARM2
    s_mul_i32 s40, s3, 1920
    s_add_u32 s40, s40, 264192
    v_min_u32 v125, 14, v0
    v_lshlrev_b32 v125, 7, v125
    s_cmp_eq_u32 s20, 1
    s_cselect_b32 s44, s14, s12
    s_cselect_b32 s45, s15, s13
    s_mov_b32 s46, 1409024
    s_mov_b32 s47, 0x00020000
    buffer_load_dword v126, v125, s[44:47], s40 offen
    s_branch L_WARMED
L_WARM2:
    s_mov_b32 s40, s3
    s_cmp_eq_u32 s20, 2
    s_cbranch_scc0 L_WARM3
    s_mul_i32 s40, s3, 9
    v_min_u32 v125, 17, v0
    v_and_b32 v126, 1, v125
    v_lshrrev_b32 v125, 1, v125
    v_add_u32 v125, s40, v125
    v_min_u32 v125, 2047, v125
    v_lshlrev_b32 v126, 7, v126
    v_and_b32 v127, 31, v125
    v_lshl_add_u32 v126, v127, 16, v126
    v_bfe_u32 v127, v125, 5, 1
    v_lshl_add_u32 v126, v127, 15, v126
    v_lshrrev_b32 v127, 6, v125
    v_lshl_add_u32 v125, v127, 10, v126
    buffer_load_dword v126, v125, s[24:27], 0 offen offset:256
    s_branch L_WARMED
L_WARM3:
    s_lshl_b32 s41, s40, 11
    s_add_u32 s41, s41, 256
    s_cmp_lt_u32 s40, 129
    s_cselect_b32 s40, s41, 2130706432
    v_and_b32 v125, 1, v0
    v_lshlrev_b32 v125, 7, v125
    v_bfe_u32 v126, v0, 1, 1
    v_lshl_add_u32 v125, v126, 10, v125
    s_mov_b32 s44, s8
    s_mov_b32 s45, s9
    s_mov_b32 s46, 524288
    s_mov_b32 s47, 0x00020000
    s_mov_b32 s48, s10
    s_mov_b32 s49, s11
    s_mov_b32 s50, 524288
    s_mov_b32 s51, 0x00020000
    buffer_load_dword v126, v125, s[44:47], s40 offen
    buffer_load_dword v127, v125, s[48:51], s40 offen
L_WARMED:
    s_cmp_eq_u32 s21, 0
    s_cbranch_scc0 L_MMA_DFT
    s_or_b32 s38, s2, s20
    s_cmp_eq_u32 s38, 0
    s_cbranch_scc0 L_NONONCE
    s_memrealtime s[92:93]
    s_waitcnt lgkmcnt(0)
    s_or_b32 s92, s92, 1
    v_mov_b32 v2, s92
    v_mov_b32 v3, s93
    v_mov_b32 v4, 0
    s_mov_b64 exec, 1
    buffer_store_dwordx2 v[2:3], v4, s[88:91], 0 offen sc1
    s_mov_b64 exec, -1
L_NONONCE:
    v_and_b32 v1, 15, v0
    v_lshrrev_b32 v2, 4, v0
    v_bfe_u32 v3, v0, 1, 3
    v_xor_b32 v3, v3, v2
    v_lshlrev_b32 v3, 4, v3
    v_lshl_add_u32 v3, v1, 7, v3
    s_lshl_b32 s38, s36, 13
    v_add_u32 v8, s38, v3
    v_xor_b32 v9, 64, v8
    v_bfe_u32 v3, v0, 2, 2
    v_and_b32 v4, 1, v2
    v_lshl_add_u32 v5, v2, 3, v3
    v_lshlrev_b32 v5, 8, v5
    v_lshl_or_b32 v3, v3, 1, v4
    s_lshl_b32 s38, s37, 2
    v_xor_b32 v3, s38, v3
    v_lshl_add_u32 v5, v3, 5, v5
    v_and_b32 v4, 3, v0
    v_lshl_add_u32 v5, v4, 3, v5
    v_add_u32 v12, 49152, v5
    v_xor_b32 v13, 32, v12
    v_xor_b32 v14, 64, v12
    v_xor_b32 v15, 96, v12
    v_mov_b32 v128, 0
    v_mov_b32 v129, 0
    v_mov_b32 v130, 0
    v_mov_b32 v131, 0
    v_mov_b32 v132, 0
    v_mov_b32 v133, 0
    v_mov_b32 v134, 0
    v_mov_b32 v135, 0
    v_mov_b32 v136, 0
    v_mov_b32 v137, 0
    v_mov_b32 v138, 0
    v_mov_b32 v139, 0
    v_mov_b32 v140, 0
    v_mov_b32 v141, 0
    v_mov_b32 v142, 0
    v_mov_b32 v143, 0
    v_mov_b32 v144, 0
    v_mov_b32 v145, 0
    v_mov_b32 v146, 0
    v_mov_b32 v147, 0
    v_mov_b32 v148, 0
    v_mov_b32 v149, 0
    v_mov_b32 v150, 0
    v_mov_b32 v151, 0
    v_mov_b32 v152, 0
    v_mov_b32 v153, 0
    v_mov_b32 v154, 0
    v_mov_b32 v155, 0
    v_mov_b32 v156, 0
    v_mov_b32 v157, 0
    v_mov_b32 v158, 0
    v_mov_b32 v159, 0
    v_mov_b32 v160, 0
    v_mov_b32 v161, 0
    v_mov_b32 v162, 0
    v_mov_b32 v163, 0
    v_mov_b32 v164, 0
    v_mov_b32 v165, 0
    v_mov_b32 v166, 0
    v_mov_b32 v167, 0
    v_mov_b32 v168, 0
    v_mov_b32 v169, 0
    v_mov_b32 v170, 0
    v_mov_b32 v171, 0
    v_mov_b32 v172, 0
    v_mov_b32 v173, 0
    v_mov_b32 v174, 0
    v_mov_b32 v175, 0
    v_mov_b32 v176, 0
    v_mov_b32 v177, 0
    v_mov_b32 v178, 0
    v_mov_b32 v179, 0
    v_mov_b32 v180, 0
    v_mov_b32 v181, 0
    v_mov_b32 v182, 0
    v_mov_b32 v183, 0
    v_mov_b32 v184, 0
    v_mov_b32 v185, 0
    v_mov_b32 v186, 0
    v_mov_b32 v187, 0
    v_mov_b32 v188, 0
    v_mov_b32 v189, 0
    v_mov_b32 v190, 0
    v_mov_b32 v191, 0
    v_mov_b32 v192, 0
    v_mov_b32 v193, 0
    v_mov_b32 v194, 0
    v_mov_b32 v195, 0
    v_mov_b32 v196, 0
    v_mov_b32 v197, 0
    v_mov_b32 v198, 0
    v_mov_b32 v199, 0
    v_mov_b32 v200, 0
    v_mov_b32 v201, 0
    v_mov_b32 v202, 0
    v_mov_b32 v203, 0
    v_mov_b32 v204, 0
    v_mov_b32 v205, 0
    v_mov_b32 v206, 0
    v_mov_b32 v207, 0
    v_mov_b32 v208, 0
    v_mov_b32 v209, 0
    v_mov_b32 v210, 0
    v_mov_b32 v211, 0
    v_mov_b32 v212, 0
    v_mov_b32 v213, 0
    v_mov_b32 v214, 0
    v_mov_b32 v215, 0
    v_mov_b32 v216, 0
    v_mov_b32 v217, 0
    v_mov_b32 v218, 0
    v_mov_b32 v219, 0
    v_mov_b32 v220, 0
    v_mov_b32 v221, 0
    v_mov_b32 v222, 0
    v_mov_b32 v223, 0
    v_mov_b32 v224, 0
    v_mov_b32 v225, 0
    v_mov_b32 v226, 0
    v_mov_b32 v227, 0
    v_mov_b32 v228, 0
    v_mov_b32 v229, 0
    v_mov_b32 v230, 0
    v_mov_b32 v231, 0
    v_mov_b32 v232, 0
    v_mov_b32 v233, 0
    v_mov_b32 v234, 0
    v_mov_b32 v235, 0
    v_mov_b32 v236, 0
    v_mov_b32 v237, 0
    v_mov_b32 v238, 0
    v_mov_b32 v239, 0
    v_mov_b32 v240, 0
    v_mov_b32 v241, 0
    v_mov_b32 v242, 0
    v_mov_b32 v243, 0
    v_mov_b32 v244, 0
    v_mov_b32 v245, 0
    v_mov_b32 v246, 0
    v_mov_b32 v247, 0
    v_mov_b32 v248, 0
    v_mov_b32 v249, 0
    v_mov_b32 v250, 0
    v_mov_b32 v251, 0
    v_mov_b32 v252, 0
    v_mov_b32 v253, 0
    v_mov_b32 v254, 0
    v_mov_b32 v255, 0
    s_lshl_b32 s38, s37, 9
    s_add_u32 s38, s38, 161792
    v_lshlrev_b32 v3, 4, v2
    v_add_u32 v112, s38, v3
    s_lshl_b32 s38, s36, 11
    s_add_u32 s38, s38, 155648
    v_lshlrev_b32 v4, 5, v1
    v_add_u32 v113, s38, v4
    s_lshl_b32 s38, s22, 1
    s_add_u32 s38, s38, s36
    s_lshl_b32 s78, s38, 9
    s_add_u32 s78, s78, 9535488
    s_mul_i32 s38, s38, 176128
    v_lshrrev_b32 v5, 1, v2
    v_lshlrev_b32 v5, 9, v5
    v_and_b32 v7, 1, v2
    v_lshl_add_u32 v7, v7, 3, v5
    v_lshl_add_u32 v5, v1, 4, v7
    v_add_u32 v114, s38, v5
    v_add_u32 v115, 256, v114
    v_add_u32 v116, 88064, v114
    v_add_u32 v117, 88320, v114
    v_mov_b32 v118, 162832
    v_mov_b32 v119, 0
    v_and_b32 v5, 15, v0
    v_lshlrev_b32 v5, 6, v5
    v_bfe_u32 v7, v0, 4, 1
    v_mul_u32_u24 v7, 88064, v7
    v_add3_u32 v123, v5, v7, s38
    v_mov_b32 v122, 162848
    v_mov_b32 v124, 1
    s_lshl_b32 s79, s23, 3
    s_lshl_b32 s39, s37, 2
    s_add_u32 s79, s79, s39
    s_mov_b32 s56, 0
    s_mov_b32 s57, 0
    s_setprio 0
    s_barrier
    ds_read_b128 v[16:19], v8 offset:0
    ds_read_b64_tr_b16 v[48:49], v12 offset:0
    ds_read_b64_tr_b16 v[50:51], v12 offset:1024
    ds_read_b128 v[20:23], v8 offset:2048
    ds_read_b128 v[24:27], v8 offset:4096
    ds_read_b128 v[28:31], v8 offset:6144
    ds_read_b64_tr_b16 v[52:53], v12 offset:16384
    ds_read_b64_tr_b16 v[54:55], v12 offset:17408
    ds_read_b64_tr_b16 v[56:57], v13 offset:0
    ds_read_b64_tr_b16 v[58:59], v13 offset:1024
    ds_read_b64_tr_b16 v[60:61], v13 offset:16384
    ds_read_b64_tr_b16 v[62:63], v13 offset:17408
    ds_read_b64_tr_b16 v[64:65], v14 offset:0
    ds_read_b64_tr_b16 v[66:67], v14 offset:1024
    ds_read_b64_tr_b16 v[68:69], v14 offset:16384
    ds_read_b64_tr_b16 v[70:71], v14 offset:17408
    ds_read_b64_tr_b16 v[72:73], v15 offset:0
    ds_read_b64_tr_b16 v[74:75], v15 offset:1024
    ds_read_b64_tr_b16 v[76:77], v15 offset:16384
    ds_read_b64_tr_b16 v[78:79], v15 offset:17408
    s_waitcnt lgkmcnt(12)
    .p2align 3
L_FLOOP:
    s_waitcnt lgkmcnt(8)
    v_mfma_f32_16x16x32_bf16 v[128:131], v[48:51], v[16:19], v[128:131]
    ds_read_b128 v[32:35], v9 offset:0
    v_mfma_f32_16x16x32_bf16 v[132:135], v[48:51], v[20:23], v[132:135]
    ds_read_b64_tr_b16 v[80:81], v12 offset:8192
    v_mfma_f32_16x16x32_bf16 v[136:139], v[48:51], v[24:27], v[136:139]
    ds_read_b64_tr_b16 v[82:83], v12 offset:9216
    v_mfma_f32_16x16x32_bf16 v[140:143], v[48:51], v[28:31], v[140:143]
    ds_read_b128 v[36:39], v9 offset:2048
    v_mfma_f32_16x16x32_bf16 v[144:147], v[52:55], v[16:19], v[144:147]
    ds_read_b128 v[40:43], v9 offset:4096
    v_mfma_f32_16x16x32_bf16 v[148:151], v[52:55], v[20:23], v[148:151]
    ds_read_b128 v[44:47], v9 offset:6144
    v_mfma_f32_16x16x32_bf16 v[152:155], v[52:55], v[24:27], v[152:155]
    ds_read_b64_tr_b16 v[84:85], v12 offset:24576
    v_mfma_f32_16x16x32_bf16 v[156:159], v[52:55], v[28:31], v[156:159]
    ds_read_b64_tr_b16 v[86:87], v12 offset:25600
    v_mfma_f32_16x16x32_bf16 v[160:163], v[56:59], v[16:19], v[160:163]
    ds_read_b64_tr_b16 v[88:89], v13 offset:8192
    v_mfma_f32_16x16x32_bf16 v[164:167], v[56:59], v[20:23], v[164:167]
    ds_read_b64_tr_b16 v[90:91], v13 offset:9216
    v_mfma_f32_16x16x32_bf16 v[168:171], v[56:59], v[24:27], v[168:171]
    ds_read_b64_tr_b16 v[92:93], v13 offset:24576
    v_mfma_f32_16x16x32_bf16 v[172:175], v[56:59], v[28:31], v[172:175]
    ds_read_b64_tr_b16 v[94:95], v13 offset:25600
    s_waitcnt lgkmcnt(12)
    v_mfma_f32_16x16x32_bf16 v[176:179], v[60:63], v[16:19], v[176:179]
    ds_read_b64_tr_b16 v[96:97], v14 offset:8192
    v_mfma_f32_16x16x32_bf16 v[180:183], v[60:63], v[20:23], v[180:183]
    ds_read_b64_tr_b16 v[98:99], v14 offset:9216
    v_mfma_f32_16x16x32_bf16 v[184:187], v[60:63], v[24:27], v[184:187]
    ds_read_b64_tr_b16 v[100:101], v14 offset:24576
    v_mfma_f32_16x16x32_bf16 v[188:191], v[60:63], v[28:31], v[188:191]
    ds_read_b64_tr_b16 v[102:103], v14 offset:25600
    v_mfma_f32_16x16x32_bf16 v[192:195], v[64:67], v[16:19], v[192:195]
    ds_read_b64_tr_b16 v[104:105], v15 offset:8192
    v_mfma_f32_16x16x32_bf16 v[196:199], v[64:67], v[20:23], v[196:199]
    ds_read_b64_tr_b16 v[106:107], v15 offset:9216
    v_mfma_f32_16x16x32_bf16 v[200:203], v[64:67], v[24:27], v[200:203]
    ds_read_b64_tr_b16 v[108:109], v15 offset:24576
    v_mfma_f32_16x16x32_bf16 v[204:207], v[64:67], v[28:31], v[204:207]
    ds_read_b64_tr_b16 v[110:111], v15 offset:25600
    v_mfma_f32_16x16x32_bf16 v[208:211], v[68:71], v[16:19], v[208:211]
    s_add_u32 s57, s57, 1
    v_mfma_f32_16x16x32_bf16 v[212:215], v[68:71], v[20:23], v[212:215]
    s_cmp_eq_u32 s57, 3
    v_mfma_f32_16x16x32_bf16 v[216:219], v[68:71], v[24:27], v[216:219]
    s_cselect_b32 s58, -2, 1
    v_mfma_f32_16x16x32_bf16 v[220:223], v[68:71], v[28:31], v[220:223]
    s_cselect_b32 s57, 0, s57
    v_mfma_f32_16x16x32_bf16 v[224:227], v[72:75], v[16:19], v[224:227]
    s_lshl_b32 s59, s58, 15
    v_mfma_f32_16x16x32_bf16 v[228:231], v[72:75], v[20:23], v[228:231]
    s_lshl_b32 s58, s58, 14
    v_mfma_f32_16x16x32_bf16 v[232:235], v[72:75], v[24:27], v[232:235]
    v_add_u32 v8, s58, v8
    v_mfma_f32_16x16x32_bf16 v[236:239], v[72:75], v[28:31], v[236:239]
    v_add_u32 v9, s58, v9
    v_mfma_f32_16x16x32_bf16 v[240:243], v[76:79], v[16:19], v[240:243]
    v_add_u32 v12, s59, v12
    v_mfma_f32_16x16x32_bf16 v[244:247], v[76:79], v[20:23], v[244:247]
    v_add_u32 v13, s59, v13
    v_mfma_f32_16x16x32_bf16 v[248:251], v[76:79], v[24:27], v[248:251]
    v_add_u32 v14, s59, v14
    v_mfma_f32_16x16x32_bf16 v[252:255], v[76:79], v[28:31], v[252:255]
    v_add_u32 v15, s59, v15
    s_waitcnt lgkmcnt(8)
    v_mfma_f32_16x16x32_bf16 v[128:131], v[80:83], v[32:35], v[128:131]
    s_waitcnt lgkmcnt(0)
    s_cmp_ge_u32 s56, 6
    s_cbranch_scc1 L_SOFT
    s_barrier
L_SOFTB:
    v_mfma_f32_16x16x32_bf16 v[132:135], v[80:83], v[36:39], v[132:135]
    ds_read_b128 v[16:19], v8 offset:0
    v_mfma_f32_16x16x32_bf16 v[136:139], v[80:83], v[40:43], v[136:139]
    ds_read_b64_tr_b16 v[48:49], v12 offset:0
    v_mfma_f32_16x16x32_bf16 v[140:143], v[80:83], v[44:47], v[140:143]
    ds_read_b64_tr_b16 v[50:51], v12 offset:1024
    v_mfma_f32_16x16x32_bf16 v[144:147], v[84:87], v[32:35], v[144:147]
    ds_read_b128 v[20:23], v8 offset:2048
    v_mfma_f32_16x16x32_bf16 v[148:151], v[84:87], v[36:39], v[148:151]
    ds_read_b128 v[24:27], v8 offset:4096
    v_mfma_f32_16x16x32_bf16 v[152:155], v[84:87], v[40:43], v[152:155]
    ds_read_b128 v[28:31], v8 offset:6144
    v_mfma_f32_16x16x32_bf16 v[156:159], v[84:87], v[44:47], v[156:159]
    ds_read_b64_tr_b16 v[52:53], v12 offset:16384
    v_mfma_f32_16x16x32_bf16 v[160:163], v[88:91], v[32:35], v[160:163]
    ds_read_b64_tr_b16 v[54:55], v12 offset:17408
    v_mfma_f32_16x16x32_bf16 v[164:167], v[88:91], v[36:39], v[164:167]
    ds_read_b64_tr_b16 v[56:57], v13 offset:0
    v_mfma_f32_16x16x32_bf16 v[168:171], v[88:91], v[40:43], v[168:171]
    ds_read_b64_tr_b16 v[58:59], v13 offset:1024
    v_mfma_f32_16x16x32_bf16 v[172:175], v[88:91], v[44:47], v[172:175]
    ds_read_b64_tr_b16 v[60:61], v13 offset:16384
    v_mfma_f32_16x16x32_bf16 v[176:179], v[92:95], v[32:35], v[176:179]
    ds_read_b64_tr_b16 v[62:63], v13 offset:17408
    v_mfma_f32_16x16x32_bf16 v[180:183], v[92:95], v[36:39], v[180:183]
    ds_read_b64_tr_b16 v[64:65], v14 offset:0
    v_mfma_f32_16x16x32_bf16 v[184:187], v[92:95], v[40:43], v[184:187]
    ds_read_b64_tr_b16 v[66:67], v14 offset:1024
    v_mfma_f32_16x16x32_bf16 v[188:191], v[92:95], v[44:47], v[188:191]
    ds_read_b64_tr_b16 v[68:69], v14 offset:16384
    v_mfma_f32_16x16x32_bf16 v[192:195], v[96:99], v[32:35], v[192:195]
    ds_read_b64_tr_b16 v[70:71], v14 offset:17408
    v_mfma_f32_16x16x32_bf16 v[196:199], v[96:99], v[36:39], v[196:199]
    ds_read_b64_tr_b16 v[72:73], v15 offset:0
    v_mfma_f32_16x16x32_bf16 v[200:203], v[96:99], v[40:43], v[200:203]
    ds_read_b64_tr_b16 v[74:75], v15 offset:1024
    v_mfma_f32_16x16x32_bf16 v[204:207], v[96:99], v[44:47], v[204:207]
    ds_read_b64_tr_b16 v[76:77], v15 offset:16384
    v_mfma_f32_16x16x32_bf16 v[208:211], v[100:103], v[32:35], v[208:211]
    ds_read_b64_tr_b16 v[78:79], v15 offset:17408
    v_mfma_f32_16x16x32_bf16 v[212:215], v[100:103], v[36:39], v[212:215]
    v_mfma_f32_16x16x32_bf16 v[216:219], v[100:103], v[40:43], v[216:219]
    v_mfma_f32_16x16x32_bf16 v[220:223], v[100:103], v[44:47], v[220:223]
    v_mfma_f32_16x16x32_bf16 v[224:227], v[104:107], v[32:35], v[224:227]
    v_mfma_f32_16x16x32_bf16 v[228:231], v[104:107], v[36:39], v[228:231]
    v_mfma_f32_16x16x32_bf16 v[232:235], v[104:107], v[40:43], v[232:235]
    v_mfma_f32_16x16x32_bf16 v[236:239], v[104:107], v[44:47], v[236:239]
    v_mfma_f32_16x16x32_bf16 v[240:243], v[108:111], v[32:35], v[240:243]
    v_mfma_f32_16x16x32_bf16 v[244:247], v[108:111], v[36:39], v[244:247]
    v_mfma_f32_16x16x32_bf16 v[248:251], v[108:111], v[40:43], v[248:251]
    s_add_u32 s56, s56, 1
    s_cmp_lt_u32 s56, 8
    v_mfma_f32_16x16x32_bf16 v[252:255], v[108:111], v[44:47], v[252:255]
    s_waitcnt lgkmcnt(12)
    s_cbranch_scc1 L_FLOOP
    s_setprio 0
    s_waitcnt lgkmcnt(0)
    s_mov_b32 s44, 0
L_CB8:
    ds_read_b32 v120, v122 offset:4
    s_add_u32 s44, s44, 1
    s_waitcnt lgkmcnt(0)
    v_readfirstlane_b32 s45, v120
    s_cmp_ge_u32 s44, 524288
    s_cbranch_scc1 L_CB8_OK
    s_cmp_lt_u32 s45, 8
    s_cbranch_scc1 L_CB8
L_CB8_OK:
    ds_read_b96 v[120:122], v118
    ds_read_b128 v[16:19], v113 offset:0
    ds_read_b128 v[20:23], v113 offset:16
    ds_read_b128 v[24:27], v113 offset:512
    ds_read_b128 v[28:31], v113 offset:528
    ds_read_b128 v[32:35], v113 offset:1024
    ds_read_b128 v[36:39], v113 offset:1040
    ds_read_b128 v[40:43], v113 offset:1536
    ds_read_b128 v[44:47], v113 offset:1552
    ds_read_b128 v[48:51], v112 offset:0
    ds_read_b128 v[52:55], v112 offset:64
    s_lshl_b32 s77, s79, 2
    s_add_u32 s77, s77, s78
    s_waitcnt lgkmcnt(2)
    v_cmp_ne_u32 vcc, 0, v120
    v_readfirstlane_b32 s92, v121
    v_readfirstlane_b32 s93, v122
    v_mov_b32 v120, v121
    ds_read_b128 v[56:59], v112 offset:128
    ds_read_b128 v[60:63], v112 offset:192
    s_waitcnt lgkmcnt(2)
    s_add_u32 s39, s79, 0
    s_lshl_b32 s39, s39, 10
    v_pk_fma_f32 v[128:129], v[16:17], v[48:49], v[128:129]
    v_pk_fma_f32 v[130:131], v[16:17], v[50:51], v[130:131]
    v_pk_fma_f32 v[132:133], v[24:25], v[48:49], v[132:133]
    v_pk_fma_f32 v[134:135], v[24:25], v[50:51], v[134:135]
    v_pk_mul_f32 v[72:73], v[128:129], v[128:129]
    v_pk_mul_f32 v[74:75], v[130:131], v[130:131]
    v_pk_mul_f32 v[76:77], v[132:133], v[132:133]
    v_pk_mul_f32 v[78:79], v[134:135], v[134:135]
    v_pk_fma_f32 v[72:73], v[72:73], v[20:21], v[18:19]
    v_pk_fma_f32 v[74:75], v[74:75], v[20:21], v[18:19]
    v_pk_fma_f32 v[76:77], v[76:77], v[28:29], v[26:27]
    v_pk_fma_f32 v[78:79], v[78:79], v[28:29], v[26:27]
    v_pk_mul_f32 v[72:73], v[72:73], v[128:129]
    v_pk_mul_f32 v[74:75], v[74:75], v[130:131]
    v_pk_mul_f32 v[76:77], v[76:77], v[132:133]
    v_pk_mul_f32 v[78:79], v[78:79], v[134:135]
    v_exp_f32 v72, v72
    v_exp_f32 v73, v73
    v_exp_f32 v74, v74
    v_exp_f32 v75, v75
    v_exp_f32 v76, v76
    v_exp_f32 v77, v77
    v_exp_f32 v78, v78
    v_exp_f32 v79, v79
    v_pk_fma_f32 v[144:145], v[16:17], v[52:53], v[144:145]
    v_pk_fma_f32 v[146:147], v[16:17], v[54:55], v[146:147]
    v_pk_fma_f32 v[148:149], v[24:25], v[52:53], v[148:149]
    v_pk_fma_f32 v[150:151], v[24:25], v[54:55], v[150:151]
    v_pk_fma_f32 v[72:73], v[72:73], v[22:23], v[22:23]
    v_pk_fma_f32 v[74:75], v[74:75], v[22:23], v[22:23]
    v_pk_fma_f32 v[76:77], v[76:77], v[30:31], v[30:31]
    v_pk_fma_f32 v[78:79], v[78:79], v[30:31], v[30:31]
    v_rcp_f32 v72, v72
    v_rcp_f32 v73, v73
    v_rcp_f32 v74, v74
    v_rcp_f32 v75, v75
    v_rcp_f32 v76, v76
    v_rcp_f32 v77, v77
    v_rcp_f32 v78, v78
    v_rcp_f32 v79, v79
    v_pk_mul_f32 v[144:145], v[144:145], v[128:129]
    v_pk_mul_f32 v[146:147], v[146:147], v[130:131]
    v_pk_mul_f32 v[148:149], v[148:149], v[132:133]
    v_pk_mul_f32 v[150:151], v[150:151], v[134:135]
    v_pk_mul_f32 v[144:145], v[144:145], v[72:73]
    v_pk_mul_f32 v[146:147], v[146:147], v[74:75]
    v_pk_mul_f32 v[148:149], v[148:149], v[76:77]
    v_pk_mul_f32 v[150:151], v[150:151], v[78:79]
    v_cvt_pk_bf16_f32 v80, v144, v145
    v_cvt_pk_bf16_f32 v81, v146, v147
    v_cvt_pk_bf16_f32 v82, v148, v149
    v_cvt_pk_bf16_f32 v83, v150, v151
    buffer_store_dwordx2 v[80:81], v114, s[32:35], s39 offen sc1
    buffer_store_dwordx2 v[82:83], v115, s[32:35], s39 offen sc1
    v_pk_fma_f32 v[136:137], v[32:33], v[48:49], v[136:137]
    v_pk_fma_f32 v[138:139], v[32:33], v[50:51], v[138:139]
    v_pk_fma_f32 v[140:141], v[40:41], v[48:49], v[140:141]
    v_pk_fma_f32 v[142:143], v[40:41], v[50:51], v[142:143]
    v_pk_mul_f32 v[72:73], v[136:137], v[136:137]
    v_pk_mul_f32 v[74:75], v[138:139], v[138:139]
    v_pk_mul_f32 v[76:77], v[140:141], v[140:141]
    v_pk_mul_f32 v[78:79], v[142:143], v[142:143]
    v_pk_fma_f32 v[72:73], v[72:73], v[36:37], v[34:35]
    v_pk_fma_f32 v[74:75], v[74:75], v[36:37], v[34:35]
    v_pk_fma_f32 v[76:77], v[76:77], v[44:45], v[42:43]
    v_pk_fma_f32 v[78:79], v[78:79], v[44:45], v[42:43]
    v_pk_mul_f32 v[72:73], v[72:73], v[136:137]
    v_pk_mul_f32 v[74:75], v[74:75], v[138:139]
    v_pk_mul_f32 v[76:77], v[76:77], v[140:141]
    v_pk_mul_f32 v[78:79], v[78:79], v[142:143]
    v_exp_f32 v72, v72
    v_exp_f32 v73, v73
    v_exp_f32 v74, v74
    v_exp_f32 v75, v75
    v_exp_f32 v76, v76
    v_exp_f32 v77, v77
    v_exp_f32 v78, v78
    v_exp_f32 v79, v79
    v_pk_fma_f32 v[152:153], v[32:33], v[52:53], v[152:153]
    v_pk_fma_f32 v[154:155], v[32:33], v[54:55], v[154:155]
    v_pk_fma_f32 v[156:157], v[40:41], v[52:53], v[156:157]
    v_pk_fma_f32 v[158:159], v[40:41], v[54:55], v[158:159]
    v_pk_fma_f32 v[72:73], v[72:73], v[38:39], v[38:39]
    v_pk_fma_f32 v[74:75], v[74:75], v[38:39], v[38:39]
    v_pk_fma_f32 v[76:77], v[76:77], v[46:47], v[46:47]
    v_pk_fma_f32 v[78:79], v[78:79], v[46:47], v[46:47]
    v_rcp_f32 v72, v72
    v_rcp_f32 v73, v73
    v_rcp_f32 v74, v74
    v_rcp_f32 v75, v75
    v_rcp_f32 v76, v76
    v_rcp_f32 v77, v77
    v_rcp_f32 v78, v78
    v_rcp_f32 v79, v79
    v_pk_mul_f32 v[152:153], v[152:153], v[136:137]
    v_pk_mul_f32 v[154:155], v[154:155], v[138:139]
    v_pk_mul_f32 v[156:157], v[156:157], v[140:141]
    v_pk_mul_f32 v[158:159], v[158:159], v[142:143]
    v_pk_mul_f32 v[152:153], v[152:153], v[72:73]
    v_pk_mul_f32 v[154:155], v[154:155], v[74:75]
    v_pk_mul_f32 v[156:157], v[156:157], v[76:77]
    v_pk_mul_f32 v[158:159], v[158:159], v[78:79]
    v_cvt_pk_bf16_f32 v84, v152, v153
    v_cvt_pk_bf16_f32 v85, v154, v155
    v_cvt_pk_bf16_f32 v86, v156, v157
    v_cvt_pk_bf16_f32 v87, v158, v159
    buffer_store_dwordx2 v[84:85], v116, s[32:35], s39 offen sc1
    buffer_store_dwordx2 v[86:87], v117, s[32:35], s39 offen sc1
    ds_read_b128 v[48:51], v112 offset:256
    ds_read_b128 v[52:55], v112 offset:320
    s_waitcnt lgkmcnt(2)
    s_add_u32 s39, s79, 1
    s_lshl_b32 s39, s39, 10
    v_pk_fma_f32 v[160:161], v[16:17], v[56:57], v[160:161]
    v_pk_fma_f32 v[162:163], v[16:17], v[58:59], v[162:163]
    v_pk_fma_f32 v[164:165], v[24:25], v[56:57], v[164:165]
    v_pk_fma_f32 v[166:167], v[24:25], v[58:59], v[166:167]
    v_pk_mul_f32 v[72:73], v[160:161], v[160:161]
    v_pk_mul_f32 v[74:75], v[162:163], v[162:163]
    v_pk_mul_f32 v[76:77], v[164:165], v[164:165]
    v_pk_mul_f32 v[78:79], v[166:167], v[166:167]
    v_pk_fma_f32 v[72:73], v[72:73], v[20:21], v[18:19]
    v_pk_fma_f32 v[74:75], v[74:75], v[20:21], v[18:19]
    v_pk_fma_f32 v[76:77], v[76:77], v[28:29], v[26:27]
    v_pk_fma_f32 v[78:79], v[78:79], v[28:29], v[26:27]
    v_pk_mul_f32 v[72:73], v[72:73], v[160:161]
    v_pk_mul_f32 v[74:75], v[74:75], v[162:163]
    v_pk_mul_f32 v[76:77], v[76:77], v[164:165]
    v_pk_mul_f32 v[78:79], v[78:79], v[166:167]
    v_exp_f32 v72, v72
    v_exp_f32 v73, v73
    v_exp_f32 v74, v74
    v_exp_f32 v75, v75
    v_exp_f32 v76, v76
    v_exp_f32 v77, v77
    v_exp_f32 v78, v78
    v_exp_f32 v79, v79
    v_pk_fma_f32 v[176:177], v[16:17], v[60:61], v[176:177]
    v_pk_fma_f32 v[178:179], v[16:17], v[62:63], v[178:179]
    v_pk_fma_f32 v[180:181], v[24:25], v[60:61], v[180:181]
    v_pk_fma_f32 v[182:183], v[24:25], v[62:63], v[182:183]
    v_pk_fma_f32 v[72:73], v[72:73], v[22:23], v[22:23]
    v_pk_fma_f32 v[74:75], v[74:75], v[22:23], v[22:23]
    v_pk_fma_f32 v[76:77], v[76:77], v[30:31], v[30:31]
    v_pk_fma_f32 v[78:79], v[78:79], v[30:31], v[30:31]
    v_rcp_f32 v72, v72
    v_rcp_f32 v73, v73
    v_rcp_f32 v74, v74
    v_rcp_f32 v75, v75
    v_rcp_f32 v76, v76
    v_rcp_f32 v77, v77
    v_rcp_f32 v78, v78
    v_rcp_f32 v79, v79
    v_pk_mul_f32 v[176:177], v[176:177], v[160:161]
    v_pk_mul_f32 v[178:179], v[178:179], v[162:163]
    v_pk_mul_f32 v[180:181], v[180:181], v[164:165]
    v_pk_mul_f32 v[182:183], v[182:183], v[166:167]
    v_pk_mul_f32 v[176:177], v[176:177], v[72:73]
    v_pk_mul_f32 v[178:179], v[178:179], v[74:75]
    v_pk_mul_f32 v[180:181], v[180:181], v[76:77]
    v_pk_mul_f32 v[182:183], v[182:183], v[78:79]
    v_cvt_pk_bf16_f32 v88, v176, v177
    v_cvt_pk_bf16_f32 v89, v178, v179
    v_cvt_pk_bf16_f32 v90, v180, v181
    v_cvt_pk_bf16_f32 v91, v182, v183
    buffer_store_dwordx2 v[88:89], v114, s[32:35], s39 offen sc1
    buffer_store_dwordx2 v[90:91], v115, s[32:35], s39 offen sc1
    v_pk_fma_f32 v[168:169], v[32:33], v[56:57], v[168:169]
    v_pk_fma_f32 v[170:171], v[32:33], v[58:59], v[170:171]
    v_pk_fma_f32 v[172:173], v[40:41], v[56:57], v[172:173]
    v_pk_fma_f32 v[174:175], v[40:41], v[58:59], v[174:175]
    v_pk_mul_f32 v[72:73], v[168:169], v[168:169]
    v_pk_mul_f32 v[74:75], v[170:171], v[170:171]
    v_pk_mul_f32 v[76:77], v[172:173], v[172:173]
    v_pk_mul_f32 v[78:79], v[174:175], v[174:175]
    v_pk_fma_f32 v[72:73], v[72:73], v[36:37], v[34:35]
    v_pk_fma_f32 v[74:75], v[74:75], v[36:37], v[34:35]
    v_pk_fma_f32 v[76:77], v[76:77], v[44:45], v[42:43]
    v_pk_fma_f32 v[78:79], v[78:79], v[44:45], v[42:43]
    v_pk_mul_f32 v[72:73], v[72:73], v[168:169]
    v_pk_mul_f32 v[74:75], v[74:75], v[170:171]
    v_pk_mul_f32 v[76:77], v[76:77], v[172:173]
    v_pk_mul_f32 v[78:79], v[78:79], v[174:175]
    v_exp_f32 v72, v72
    v_exp_f32 v73, v73
    v_exp_f32 v74, v74
    v_exp_f32 v75, v75
    v_exp_f32 v76, v76
    v_exp_f32 v77, v77
    v_exp_f32 v78, v78
    v_exp_f32 v79, v79
    v_pk_fma_f32 v[184:185], v[32:33], v[60:61], v[184:185]
    v_pk_fma_f32 v[186:187], v[32:33], v[62:63], v[186:187]
    v_pk_fma_f32 v[188:189], v[40:41], v[60:61], v[188:189]
    v_pk_fma_f32 v[190:191], v[40:41], v[62:63], v[190:191]
    v_pk_fma_f32 v[72:73], v[72:73], v[38:39], v[38:39]
    v_pk_fma_f32 v[74:75], v[74:75], v[38:39], v[38:39]
    v_pk_fma_f32 v[76:77], v[76:77], v[46:47], v[46:47]
    v_pk_fma_f32 v[78:79], v[78:79], v[46:47], v[46:47]
    v_rcp_f32 v72, v72
    v_rcp_f32 v73, v73
    v_rcp_f32 v74, v74
    v_rcp_f32 v75, v75
    v_rcp_f32 v76, v76
    v_rcp_f32 v77, v77
    v_rcp_f32 v78, v78
    v_rcp_f32 v79, v79
    v_pk_mul_f32 v[184:185], v[184:185], v[168:169]
    v_pk_mul_f32 v[186:187], v[186:187], v[170:171]
    v_pk_mul_f32 v[188:189], v[188:189], v[172:173]
    v_pk_mul_f32 v[190:191], v[190:191], v[174:175]
    v_pk_mul_f32 v[184:185], v[184:185], v[72:73]
    v_pk_mul_f32 v[186:187], v[186:187], v[74:75]
    v_pk_mul_f32 v[188:189], v[188:189], v[76:77]
    v_pk_mul_f32 v[190:191], v[190:191], v[78:79]
    v_cvt_pk_bf16_f32 v92, v184, v185
    v_cvt_pk_bf16_f32 v93, v186, v187
    v_cvt_pk_bf16_f32 v94, v188, v189
    v_cvt_pk_bf16_f32 v95, v190, v191
    buffer_store_dwordx2 v[92:93], v116, s[32:35], s39 offen sc1
    buffer_store_dwordx2 v[94:95], v117, s[32:35], s39 offen sc1
    ds_read_b128 v[56:59], v112 offset:384
    ds_read_b128 v[60:63], v112 offset:448
    s_waitcnt lgkmcnt(2)
    s_cmp_ge_u32 s79, 84
    s_cbranch_scc1 L_MTAIL
    s_add_u32 s39, s79, 2
    s_lshl_b32 s39, s39, 10
    v_pk_fma_f32 v[192:193], v[16:17], v[48:49], v[192:193]
    v_pk_fma_f32 v[194:195], v[16:17], v[50:51], v[194:195]
    v_pk_fma_f32 v[196:197], v[24:25], v[48:49], v[196:197]
    v_pk_fma_f32 v[198:199], v[24:25], v[50:51], v[198:199]
    v_pk_mul_f32 v[72:73], v[192:193], v[192:193]
    v_pk_mul_f32 v[74:75], v[194:195], v[194:195]
    v_pk_mul_f32 v[76:77], v[196:197], v[196:197]
    v_pk_mul_f32 v[78:79], v[198:199], v[198:199]
    v_pk_fma_f32 v[72:73], v[72:73], v[20:21], v[18:19]
    v_pk_fma_f32 v[74:75], v[74:75], v[20:21], v[18:19]
    v_pk_fma_f32 v[76:77], v[76:77], v[28:29], v[26:27]
    v_pk_fma_f32 v[78:79], v[78:79], v[28:29], v[26:27]
    v_pk_mul_f32 v[72:73], v[72:73], v[192:193]
    v_pk_mul_f32 v[74:75], v[74:75], v[194:195]
    v_pk_mul_f32 v[76:77], v[76:77], v[196:197]
    v_pk_mul_f32 v[78:79], v[78:79], v[198:199]
    v_exp_f32 v72, v72
    v_exp_f32 v73, v73
    v_exp_f32 v74, v74
    v_exp_f32 v75, v75
    v_exp_f32 v76, v76
    v_exp_f32 v77, v77
    v_exp_f32 v78, v78
    v_exp_f32 v79, v79
    v_pk_fma_f32 v[208:209], v[16:17], v[52:53], v[208:209]
    v_pk_fma_f32 v[210:211], v[16:17], v[54:55], v[210:211]
    v_pk_fma_f32 v[212:213], v[24:25], v[52:53], v[212:213]
    v_pk_fma_f32 v[214:215], v[24:25], v[54:55], v[214:215]
    v_pk_fma_f32 v[72:73], v[72:73], v[22:23], v[22:23]
    v_pk_fma_f32 v[74:75], v[74:75], v[22:23], v[22:23]
    v_pk_fma_f32 v[76:77], v[76:77], v[30:31], v[30:31]
    v_pk_fma_f32 v[78:79], v[78:79], v[30:31], v[30:31]
    v_rcp_f32 v72, v72
    v_rcp_f32 v73, v73
    v_rcp_f32 v74, v74
    v_rcp_f32 v75, v75
    v_rcp_f32 v76, v76
    v_rcp_f32 v77, v77
    v_rcp_f32 v78, v78
    v_rcp_f32 v79, v79
    v_pk_mul_f32 v[208:209], v[208:209], v[192:193]
    v_pk_mul_f32 v[210:211], v[210:211], v[194:195]
    v_pk_mul_f32 v[212:213], v[212:213], v[196:197]
    v_pk_mul_f32 v[214:215], v[214:215], v[198:199]
    v_pk_mul_f32 v[208:209], v[208:209], v[72:73]
    v_pk_mul_f32 v[210:211], v[210:211], v[74:75]
    v_pk_mul_f32 v[212:213], v[212:213], v[76:77]
    v_pk_mul_f32 v[214:215], v[214:215], v[78:79]
    v_cvt_pk_bf16_f32 v80, v208, v209
    v_cvt_pk_bf16_f32 v81, v210, v211
    v_cvt_pk_bf16_f32 v82, v212, v213
    v_cvt_pk_bf16_f32 v83, v214, v215
    v_pk_fma_f32 v[200:201], v[32:33], v[48:49], v[200:201]
    v_pk_fma_f32 v[202:203], v[32:33], v[50:51], v[202:203]
    v_pk_fma_f32 v[204:205], v[40:41], v[48:49], v[204:205]
    v_pk_fma_f32 v[206:207], v[40:41], v[50:51], v[206:207]
    v_pk_mul_f32 v[72:73], v[200:201], v[200:201]
    v_pk_mul_f32 v[74:75], v[202:203], v[202:203]
    v_pk_mul_f32 v[76:77], v[204:205], v[204:205]
    v_pk_mul_f32 v[78:79], v[206:207], v[206:207]
    v_pk_fma_f32 v[72:73], v[72:73], v[36:37], v[34:35]
    v_pk_fma_f32 v[74:75], v[74:75], v[36:37], v[34:35]
    v_pk_fma_f32 v[76:77], v[76:77], v[44:45], v[42:43]
    v_pk_fma_f32 v[78:79], v[78:79], v[44:45], v[42:43]
    v_pk_mul_f32 v[72:73], v[72:73], v[200:201]
    v_pk_mul_f32 v[74:75], v[74:75], v[202:203]
    v_pk_mul_f32 v[76:77], v[76:77], v[204:205]
    v_pk_mul_f32 v[78:79], v[78:79], v[206:207]
    v_exp_f32 v72, v72
    v_exp_f32 v73, v73
    v_exp_f32 v74, v74
    v_exp_f32 v75, v75
    v_exp_f32 v76, v76
    v_exp_f32 v77, v77
    v_exp_f32 v78, v78
    v_exp_f32 v79, v79
    v_pk_fma_f32 v[216:217], v[32:33], v[52:53], v[216:217]
    v_pk_fma_f32 v[218:219], v[32:33], v[54:55], v[218:219]
    v_pk_fma_f32 v[220:221], v[40:41], v[52:53], v[220:221]
    v_pk_fma_f32 v[222:223], v[40:41], v[54:55], v[222:223]
    v_pk_fma_f32 v[72:73], v[72:73], v[38:39], v[38:39]
    v_pk_fma_f32 v[74:75], v[74:75], v[38:39], v[38:39]
    v_pk_fma_f32 v[76:77], v[76:77], v[46:47], v[46:47]
    v_pk_fma_f32 v[78:79], v[78:79], v[46:47], v[46:47]
    v_rcp_f32 v72, v72
    v_rcp_f32 v73, v73
    v_rcp_f32 v74, v74
    v_rcp_f32 v75, v75
    v_rcp_f32 v76, v76
    v_rcp_f32 v77, v77
    v_rcp_f32 v78, v78
    v_rcp_f32 v79, v79
    v_pk_mul_f32 v[216:217], v[216:217], v[200:201]
    v_pk_mul_f32 v[218:219], v[218:219], v[202:203]
    v_pk_mul_f32 v[220:221], v[220:221], v[204:205]
    v_pk_mul_f32 v[222:223], v[222:223], v[206:207]
    v_pk_mul_f32 v[216:217], v[216:217], v[72:73]
    v_pk_mul_f32 v[218:219], v[218:219], v[74:75]
    v_pk_mul_f32 v[220:221], v[220:221], v[76:77]
    v_pk_mul_f32 v[222:223], v[222:223], v[78:79]
    v_cvt_pk_bf16_f32 v84, v216, v217
    v_cvt_pk_bf16_f32 v85, v218, v219
    v_cvt_pk_bf16_f32 v86, v220, v221
    v_cvt_pk_bf16_f32 v87, v222, v223
    s_waitcnt lgkmcnt(0)
    s_add_u32 s76, s79, 3
    s_lshl_b32 s76, s76, 10
    v_pk_fma_f32 v[224:225], v[16:17], v[56:57], v[224:225]
    v_pk_fma_f32 v[226:227], v[16:17], v[58:59], v[226:227]
    v_pk_fma_f32 v[228:229], v[24:25], v[56:57], v[228:229]
    v_pk_fma_f32 v[230:231], v[24:25], v[58:59], v[230:231]
    v_pk_mul_f32 v[72:73], v[224:225], v[224:225]
    v_pk_mul_f32 v[74:75], v[226:227], v[226:227]
    v_pk_mul_f32 v[76:77], v[228:229], v[228:229]
    v_pk_mul_f32 v[78:79], v[230:231], v[230:231]
    v_pk_fma_f32 v[72:73], v[72:73], v[20:21], v[18:19]
    v_pk_fma_f32 v[74:75], v[74:75], v[20:21], v[18:19]
    v_pk_fma_f32 v[76:77], v[76:77], v[28:29], v[26:27]
    v_pk_fma_f32 v[78:79], v[78:79], v[28:29], v[26:27]
    v_pk_mul_f32 v[72:73], v[72:73], v[224:225]
    v_pk_mul_f32 v[74:75], v[74:75], v[226:227]
    v_pk_mul_f32 v[76:77], v[76:77], v[228:229]
    v_pk_mul_f32 v[78:79], v[78:79], v[230:231]
    v_exp_f32 v72, v72
    v_exp_f32 v73, v73
    v_exp_f32 v74, v74
    v_exp_f32 v75, v75
    v_exp_f32 v76, v76
    v_exp_f32 v77, v77
    v_exp_f32 v78, v78
    v_exp_f32 v79, v79
    v_pk_fma_f32 v[240:241], v[16:17], v[60:61], v[240:241]
    v_pk_fma_f32 v[242:243], v[16:17], v[62:63], v[242:243]
    v_pk_fma_f32 v[244:245], v[24:25], v[60:61], v[244:245]
    v_pk_fma_f32 v[246:247], v[24:25], v[62:63], v[246:247]
    v_pk_fma_f32 v[72:73], v[72:73], v[22:23], v[22:23]
    v_pk_fma_f32 v[74:75], v[74:75], v[22:23], v[22:23]
    v_pk_fma_f32 v[76:77], v[76:77], v[30:31], v[30:31]
    v_pk_fma_f32 v[78:79], v[78:79], v[30:31], v[30:31]
    v_rcp_f32 v72, v72
    v_rcp_f32 v73, v73
    v_rcp_f32 v74, v74
    v_rcp_f32 v75, v75
    v_rcp_f32 v76, v76
    v_rcp_f32 v77, v77
    v_rcp_f32 v78, v78
    v_rcp_f32 v79, v79
    v_pk_mul_f32 v[240:241], v[240:241], v[224:225]
    v_pk_mul_f32 v[242:243], v[242:243], v[226:227]
    v_pk_mul_f32 v[244:245], v[244:245], v[228:229]
    v_pk_mul_f32 v[246:247], v[246:247], v[230:231]
    v_pk_mul_f32 v[240:241], v[240:241], v[72:73]
    v_pk_mul_f32 v[242:243], v[242:243], v[74:75]
    v_pk_mul_f32 v[244:245], v[244:245], v[76:77]
    v_pk_mul_f32 v[246:247], v[246:247], v[78:79]
    v_cvt_pk_bf16_f32 v88, v240, v241
    v_cvt_pk_bf16_f32 v89, v242, v243
    v_cvt_pk_bf16_f32 v90, v244, v245
    v_cvt_pk_bf16_f32 v91, v246, v247
    v_pk_fma_f32 v[232:233], v[32:33], v[56:57], v[232:233]
    v_pk_fma_f32 v[234:235], v[32:33], v[58:59], v[234:235]
    v_pk_fma_f32 v[236:237], v[40:41], v[56:57], v[236:237]
    v_pk_fma_f32 v[238:239], v[40:41], v[58:59], v[238:239]
    v_pk_mul_f32 v[72:73], v[232:233], v[232:233]
    v_pk_mul_f32 v[74:75], v[234:235], v[234:235]
    v_pk_mul_f32 v[76:77], v[236:237], v[236:237]
    v_pk_mul_f32 v[78:79], v[238:239], v[238:239]
    v_pk_fma_f32 v[72:73], v[72:73], v[36:37], v[34:35]
    v_pk_fma_f32 v[74:75], v[74:75], v[36:37], v[34:35]
    v_pk_fma_f32 v[76:77], v[76:77], v[44:45], v[42:43]
    v_pk_fma_f32 v[78:79], v[78:79], v[44:45], v[42:43]
    v_pk_mul_f32 v[72:73], v[72:73], v[232:233]
    v_pk_mul_f32 v[74:75], v[74:75], v[234:235]
    v_pk_mul_f32 v[76:77], v[76:77], v[236:237]
    v_pk_mul_f32 v[78:79], v[78:79], v[238:239]
    v_exp_f32 v72, v72
    v_exp_f32 v73, v73
    v_exp_f32 v74, v74
    v_exp_f32 v75, v75
    v_exp_f32 v76, v76
    v_exp_f32 v77, v77
    v_exp_f32 v78, v78
    v_exp_f32 v79, v79
    v_pk_fma_f32 v[248:249], v[32:33], v[60:61], v[248:249]
    v_pk_fma_f32 v[250:251], v[32:33], v[62:63], v[250:251]
    v_pk_fma_f32 v[252:253], v[40:41], v[60:61], v[252:253]
    v_pk_fma_f32 v[254:255], v[40:41], v[62:63], v[254:255]
    v_pk_fma_f32 v[72:73], v[72:73], v[38:39], v[38:39]
    v_pk_fma_f32 v[74:75], v[74:75], v[38:39], v[38:39]
    v_pk_fma_f32 v[76:77], v[76:77], v[46:47], v[46:47]
    v_pk_fma_f32 v[78:79], v[78:79], v[46:47], v[46:47]
    v_rcp_f32 v72, v72
    v_rcp_f32 v73, v73
    v_rcp_f32 v74, v74
    v_rcp_f32 v75, v75
    v_rcp_f32 v76, v76
    v_rcp_f32 v77, v77
    v_rcp_f32 v78, v78
    v_rcp_f32 v79, v79
    v_pk_mul_f32 v[248:249], v[248:249], v[232:233]
    v_pk_mul_f32 v[250:251], v[250:251], v[234:235]
    v_pk_mul_f32 v[252:253], v[252:253], v[236:237]
    v_pk_mul_f32 v[254:255], v[254:255], v[238:239]
    v_pk_mul_f32 v[248:249], v[248:249], v[72:73]
    v_pk_mul_f32 v[250:251], v[250:251], v[74:75]
    v_pk_mul_f32 v[252:253], v[252:253], v[76:77]
    v_pk_mul_f32 v[254:255], v[254:255], v[78:79]
    v_cvt_pk_bf16_f32 v92, v248, v249
    v_cvt_pk_bf16_f32 v93, v250, v251
    v_cvt_pk_bf16_f32 v94, v252, v253
    v_cvt_pk_bf16_f32 v95, v254, v255
    s_waitcnt vmcnt(0)
    s_add_u32 s41, s77, 0
    s_mov_b64 exec, 1
    s_cbranch_vccz L_SA0
    buffer_store_dwordx2 v[120:121], v119, s[32:35], s41 offen
L_SB0:
    s_mov_b64 exec, -1
    buffer_store_dwordx2 v[80:81], v114, s[32:35], s39 offen sc1
    buffer_store_dwordx2 v[82:83], v115, s[32:35], s39 offen sc1
    buffer_store_dwordx2 v[84:85], v116, s[32:35], s39 offen sc1
    buffer_store_dwordx2 v[86:87], v117, s[32:35], s39 offen sc1
    buffer_store_dwordx2 v[88:89], v114, s[32:35], s76 offen sc1
    buffer_store_dwordx2 v[90:91], v115, s[32:35], s76 offen sc1
    buffer_store_dwordx2 v[92:93], v116, s[32:35], s76 offen sc1
    buffer_store_dwordx2 v[94:95], v117, s[32:35], s76 offen sc1
    s_waitcnt vmcnt(0)
    s_add_u32 s41, s77, 8
    s_mov_b64 exec, 1
    s_cbranch_vccz L_SA1
    buffer_store_dwordx2 v[120:121], v119, s[32:35], s41 offen
L_SB1:
    s_mov_b64 exec, -1
L_MDONE:
L_FIN:
    s_setprio 0
    s_and_b32 s74, s2, 7
    s_lshl_b32 s74, s74, 2
    s_lshr_b32 s75, s2, 6
    s_add_u32 s74, s74, s75
    s_bfe_u32 s75, s2, 0x30003
    s_and_b32 s45, s20, 1
    s_lshr_b32 s46, s20, 1
    s_mov_b32 s54, 9469952
    s_sub_u32 s47, 7, s75
    s_sub_u32 s48, 8, s75
    s_and_b32 s48, s48, 3
    s_cmp_lt_u32 s75, 4
    s_cselect_b32 s47, s75, s47
    s_cselect_b32 s48, s75, s48
    s_sub_u32 s48, s48, s47
    v_and_b32 v8, 15, v0
    v_lshlrev_b32 v8, 2, v8
    v_bfe_u32 v9, v0, 4, 1
    v_mul_lo_u32 v9, s48, v9
    v_add3_u32 v8, v8, v9, s47
    v_lshlrev_b32 v8, 7, v8
    buffer_load_dwordx2 v[72:73], v8, s[32:35], s54 offen sc1
    s_lshl_b32 s47, s75, 6
    s_lshl_b32 s48, s45, 5
    s_add_u32 s47, s47, s48
    s_lshl_b32 s48, s46, 5
    s_add_u32 s48, s48, s74
    s_lshl_b32 s48, s48, 10
    s_lshl_b32 s53, s47, 1
    s_add_u32 s48, s48, s53
    v_and_b32 v6, 31, v0
    v_lshrrev_b32 v7, 5, v0
    v_lshlrev_b32 v5, 16, v6
    v_lshl_add_u32 v5, v7, 4, v5
    v_add_u32 v5, s48, v5
    buffer_load_dwordx4 v[64:67], v5, s[24:27], 0 offen
    buffer_load_dwordx4 v[68:71], v5, s[24:27], 0 offen offset:32
    s_cmp_lg_u32 s74, 0
    s_cselect_b32 s76, s46, 0
    s_sub_u32 s77, s46, s76
    s_sub_u32 s78, 32, s74
    s_cmp_eq_u32 s46, 0
    s_cselect_b32 s78, s74, s78
    s_mul_i32 s78, s78, 2048
    s_add_u32 s78, s78, 6291456
    v_add_u32 v1, s47, v6
    v_sub_u32 v2, 512, v1
    v_and_b32 v2, 511, v2
    v_sub_u32 v3, 31, v6
    s_cmp_eq_u32 s76, 1
    s_cselect_b64 vcc, -1, 0
    v_cndmask_b32 v1, v1, v2, vcc
    v_cndmask_b32 v6, v6, v3, vcc
    v_sub_u32 v2, 512, v1
    v_and_b32 v2, 255, v2
    v_or_b32 v2, 256, v2
    v_cmp_gt_u32 vcc, 256, v1
    s_nop 1
    v_cndmask_b32 v1, v2, v1, vcc
    v_mul_u32_u24 v2, 270336, v7
    v_lshl_add_u32 v1, v1, 2, v2
    v_lshlrev_b32 v6, 1, v6
    v_add_u32 v6, s77, v6
    v_cvt_f32_u32 v6, v6
    v_mul_f32 v6, 0x3c800000, v6
    v_cvt_f32_u32 v7, v7
    v_mul_f32 v7, 4.0, v7
    v_mul_f32 v7, v7, v6
    v_fmamk_f32 v2, v6, 0x00000000, v7
    v_cos_f32 v3, v2
    v_sin_f32 v4, v2
    s_nop 0
    v_cvt_pk_bf16_f32 v48, v3, v4
    v_fmamk_f32 v2, v6, 0x3f800000, v7
    v_cos_f32 v3, v2
    v_sin_f32 v4, v2
    s_nop 0
    v_cvt_pk_bf16_f32 v49, v3, v4
    v_fmamk_f32 v2, v6, 0x40000000, v7
    v_cos_f32 v3, v2
    v_sin_f32 v4, v2
    s_nop 0
    v_cvt_pk_bf16_f32 v50, v3, v4
    v_fmamk_f32 v2, v6, 0x40400000, v7
    v_cos_f32 v3, v2
    v_sin_f32 v4, v2
    s_nop 0
    v_cvt_pk_bf16_f32 v51, v3, v4
    v_fmamk_f32 v2, v6, 0x41000000, v7
    v_cos_f32 v3, v2
    v_sin_f32 v4, v2
    s_nop 0
    v_cvt_pk_bf16_f32 v52, v3, v4
    v_fmamk_f32 v2, v6, 0x41100000, v7
    v_cos_f32 v3, v2
    v_sin_f32 v4, v2
    s_nop 0
    v_cvt_pk_bf16_f32 v53, v3, v4
    v_fmamk_f32 v2, v6, 0x41200000, v7
    v_cos_f32 v3, v2
    v_sin_f32 v4, v2
    s_nop 0
    v_cvt_pk_bf16_f32 v54, v3, v4
    v_fmamk_f32 v2, v6, 0x41300000, v7
    v_cos_f32 v3, v2
    v_sin_f32 v4, v2
    s_nop 0
    v_cvt_pk_bf16_f32 v55, v3, v4
    s_waitcnt vmcnt(2)
    s_mov_b32 s56, 0
L_FD:
    v_cmp_eq_u32 vcc, s92, v72
    v_cmp_eq_u32 s[38:39], s93, v73
    s_add_u32 s56, s56, 1
    s_nop 2
    s_and_b64 vcc, vcc, s[38:39]
    s_cmp_eq_u64 vcc, -1
    s_cbranch_scc1 L_FD_OK
    s_cmp_ge_u32 s56, 32768
    s_cbranch_scc1 L_FD_OK
    s_sleep 16
    buffer_load_dwordx2 v[72:73], v8, s[32:35], s54 offen sc1
    s_waitcnt vmcnt(0)
    s_branch L_FD
L_FD_OK:
    s_add_u32 s53, s78, 0
    buffer_load_dword v32, v1, s[32:35], s53 offen sc1
    s_add_u32 s53, s78, 67584
    buffer_load_dword v33, v1, s[32:35], s53 offen sc1
    s_add_u32 s53, s78, 135168
    buffer_load_dword v34, v1, s[32:35], s53 offen sc1
    s_add_u32 s53, s78, 202752
    buffer_load_dword v35, v1, s[32:35], s53 offen sc1
    s_add_u32 s53, s78, 540672
    buffer_load_dword v36, v1, s[32:35], s53 offen sc1
    s_add_u32 s53, s78, 608256
    buffer_load_dword v37, v1, s[32:35], s53 offen sc1
    s_add_u32 s53, s78, 675840
    buffer_load_dword v38, v1, s[32:35], s53 offen sc1
    s_add_u32 s53, s78, 743424
    buffer_load_dword v39, v1, s[32:35], s53 offen sc1
    s_add_u32 s53, s78, 1081344
    buffer_load_dword v40, v1, s[32:35], s53 offen sc1
    s_add_u32 s53, s78, 1148928
    buffer_load_dword v41, v1, s[32:35], s53 offen sc1
    s_add_u32 s53, s78, 1216512
    buffer_load_dword v42, v1, s[32:35], s53 offen sc1
    s_add_u32 s53, s78, 1284096
    buffer_load_dword v43, v1, s[32:35], s53 offen sc1
    s_add_u32 s53, s78, 1622016
    buffer_load_dword v44, v1, s[32:35], s53 offen sc1
    s_add_u32 s53, s78, 1689600
    buffer_load_dword v45, v1, s[32:35], s53 offen sc1
    s_add_u32 s53, s78, 1757184
    buffer_load_dword v46, v1, s[32:35], s53 offen sc1
    s_add_u32 s53, s78, 1824768
    buffer_load_dword v47, v1, s[32:35], s53 offen sc1
    v_fmamk_f32 v2, v6, 0x41800000, v7
    v_cos_f32 v3, v2
    v_sin_f32 v4, v2
    s_nop 0
    v_cvt_pk_bf16_f32 v56, v3, v4
    v_fmamk_f32 v2, v6, 0x41880000, v7
    v_cos_f32 v3, v2
    v_sin_f32 v4, v2
    s_nop 0
    v_cvt_pk_bf16_f32 v57, v3, v4
    v_fmamk_f32 v2, v6, 0x41900000, v7
    v_cos_f32 v3, v2
    v_sin_f32 v4, v2
    s_nop 0
    v_cvt_pk_bf16_f32 v58, v3, v4
    v_fmamk_f32 v2, v6, 0x41980000, v7
    v_cos_f32 v3, v2
    v_sin_f32 v4, v2
    s_nop 0
    v_cvt_pk_bf16_f32 v59, v3, v4
    v_fmamk_f32 v2, v6, 0x41c00000, v7
    v_cos_f32 v3, v2
    v_sin_f32 v4, v2
    s_nop 0
    v_cvt_pk_bf16_f32 v60, v3, v4
    v_fmamk_f32 v2, v6, 0x41c80000, v7
    v_cos_f32 v3, v2
    v_sin_f32 v4, v2
    s_nop 0
    v_cvt_pk_bf16_f32 v61, v3, v4
    v_fmamk_f32 v2, v6, 0x41d00000, v7
    v_cos_f32 v3, v2
    v_sin_f32 v4, v2
    s_nop 0
    v_cvt_pk_bf16_f32 v62, v3, v4
    v_fmamk_f32 v2, v6, 0x41d80000, v7
    v_cos_f32 v3, v2
    v_sin_f32 v4, v2
    s_nop 0
    v_cvt_pk_bf16_f32 v63, v3, v4
    s_mov_b32 s48, 0xffff0000
    s_lshl_b32 s53, s45, 12
    s_lshl_b32 s54, s46, 15
    s_add_u32 s53, s53, s54
    s_add_u32 s53, s53, 49152
    v_lshlrev_b32 v9, 4, v0
    v_add_u32 v9, s53, v9
    s_waitcnt vmcnt(16)
    v_permlane32_swap_b32 v64, v66
    v_permlane32_swap_b32 v65, v67
    v_permlane32_swap_b32 v68, v70
    v_permlane32_swap_b32 v69, v71
    v_lshlrev_b32 v80, 16, v64
    v_and_b32 v81, s48, v64
    v_lshlrev_b32 v82, 16, v65
    v_and_b32 v83, s48, v65
    v_lshlrev_b32 v84, 16, v66
    v_and_b32 v85, s48, v66
    v_lshlrev_b32 v86, 16, v67
    v_and_b32 v87, s48, v67
    v_lshlrev_b32 v88, 16, v68
    v_and_b32 v89, s48, v68
    v_lshlrev_b32 v90, 16, v69
    v_and_b32 v91, s48, v69
    v_lshlrev_b32 v92, 16, v70
    v_and_b32 v93, s48, v70
    v_lshlrev_b32 v94, 16, v71
    v_and_b32 v95, s48, v71
    s_waitcnt vmcnt(0)
    v_mfma_f32_32x32x16_bf16 v[16:31], v[32:35], v[48:51], 0
    v_mfma_f32_32x32x16_bf16 v[16:31], v[36:39], v[52:55], v[16:31]
    v_mfma_f32_32x32x16_bf16 v[16:31], v[40:43], v[56:59], v[16:31]
    v_mfma_f32_32x32x16_bf16 v[16:31], v[44:47], v[60:63], v[16:31]
    s_mov_b32 s24, s82
    s_mov_b32 s25, s83
    s_barrier
    ds_read_b128 v[96:99], v9 offset:0
    ds_read_b128 v[100:103], v9 offset:1024
    ds_read_b128 v[104:107], v9 offset:2048
    ds_read_b128 v[108:111], v9 offset:3072
    ds_read_b128 v[112:115], v9 offset:8192
    ds_read_b128 v[116:119], v9 offset:9216
    ds_read_b128 v[120:123], v9 offset:10240
    ds_read_b128 v[124:127], v9 offset:11264
    ds_read_b128 v[128:131], v9 offset:16384
    ds_read_b128 v[132:135], v9 offset:17408
    ds_read_b128 v[136:139], v9 offset:18432
    ds_read_b128 v[140:143], v9 offset:19456
    s_waitcnt lgkmcnt(8)
    ds_read_b128 v[144:147], v9 offset:24576
    ds_read_b128 v[148:151], v9 offset:25600
    ds_read_b128 v[152:155], v9 offset:26624
    ds_read_b128 v[156:159], v9 offset:27648
    s_waitcnt lgkmcnt(8)
    v_pk_add_f32 v[96:97], v[96:97], v[112:113]
    v_pk_add_f32 v[98:99], v[98:99], v[114:115]
    v_pk_add_f32 v[100:101], v[100:101], v[116:117]
    v_pk_add_f32 v[102:103], v[102:103], v[118:119]
    v_pk_add_f32 v[104:105], v[104:105], v[120:121]
    v_pk_add_f32 v[106:107], v[106:107], v[122:123]
    v_pk_add_f32 v[108:109], v[108:109], v[124:125]
    v_pk_add_f32 v[110:111], v[110:111], v[126:127]
    s_waitcnt lgkmcnt(4)
    v_pk_add_f32 v[96:97], v[96:97], v[128:129]
    v_pk_add_f32 v[98:99], v[98:99], v[130:131]
    v_pk_add_f32 v[100:101], v[100:101], v[132:133]
    v_pk_add_f32 v[102:103], v[102:103], v[134:135]
    v_pk_add_f32 v[104:105], v[104:105], v[136:137]
    v_pk_add_f32 v[106:107], v[106:107], v[138:139]
    v_pk_add_f32 v[108:109], v[108:109], v[140:141]
    v_pk_add_f32 v[110:111], v[110:111], v[142:143]
    s_waitcnt lgkmcnt(0)
    v_pk_add_f32 v[96:97], v[96:97], v[144:145]
    v_pk_add_f32 v[98:99], v[98:99], v[146:147]
    v_pk_add_f32 v[100:101], v[100:101], v[148:149]
    v_pk_add_f32 v[102:103], v[102:103], v[150:151]
    v_pk_add_f32 v[104:105], v[104:105], v[152:153]
    v_pk_add_f32 v[106:107], v[106:107], v[154:155]
    v_pk_add_f32 v[108:109], v[108:109], v[156:157]
    v_pk_add_f32 v[110:111], v[110:111], v[158:159]
    v_mul_f32 v112, 0xbfb8aa3b, v96
    v_mul_f32 v113, 0xbfb8aa3b, v97
    v_mul_f32 v114, 0xbfb8aa3b, v98
    v_mul_f32 v115, 0xbfb8aa3b, v99
    v_mul_f32 v116, 0xbfb8aa3b, v100
    v_mul_f32 v117, 0xbfb8aa3b, v101
    v_mul_f32 v118, 0xbfb8aa3b, v102
    v_mul_f32 v119, 0xbfb8aa3b, v103
    v_mul_f32 v120, 0xbfb8aa3b, v104
    v_mul_f32 v121, 0xbfb8aa3b, v105
    v_mul_f32 v122, 0xbfb8aa3b, v106
    v_mul_f32 v123, 0xbfb8aa3b, v107
    v_mul_f32 v124, 0xbfb8aa3b, v108
    v_mul_f32 v125, 0xbfb8aa3b, v109
    v_mul_f32 v126, 0xbfb8aa3b, v110
    v_mul_f32 v127, 0xbfb8aa3b, v111
    v_exp_f32 v112, v112
    v_exp_f32 v113, v113
    v_exp_f32 v114, v114
    v_exp_f32 v115, v115
    v_exp_f32 v116, v116
    v_exp_f32 v117, v117
    v_exp_f32 v118, v118
    v_exp_f32 v119, v119
    v_exp_f32 v120, v120
    v_exp_f32 v121, v121
    v_exp_f32 v122, v122
    v_exp_f32 v123, v123
    v_exp_f32 v124, v124
    v_exp_f32 v125, v125
    v_exp_f32 v126, v126
    v_exp_f32 v127, v127
    v_pk_mul_f32 v[96:97], v[96:97], v[16:17]
    v_pk_mul_f32 v[98:99], v[98:99], v[18:19]
    v_pk_mul_f32 v[100:101], v[100:101], v[20:21]
    v_pk_mul_f32 v[102:103], v[102:103], v[22:23]
    v_pk_mul_f32 v[104:105], v[104:105], v[24:25]
    v_pk_mul_f32 v[106:107], v[106:107], v[26:27]
    v_pk_mul_f32 v[108:109], v[108:109], v[28:29]
    v_pk_mul_f32 v[110:111], v[110:111], v[30:31]
    v_add_f32 v112, 1.0, v112
    v_add_f32 v113, 1.0, v113
    v_add_f32 v114, 1.0, v114
    v_add_f32 v115, 1.0, v115
    v_add_f32 v116, 1.0, v116
    v_add_f32 v117, 1.0, v117
    v_add_f32 v118, 1.0, v118
    v_add_f32 v119, 1.0, v119
    v_add_f32 v120, 1.0, v120
    v_add_f32 v121, 1.0, v121
    v_add_f32 v122, 1.0, v122
    v_add_f32 v123, 1.0, v123
    v_add_f32 v124, 1.0, v124
    v_add_f32 v125, 1.0, v125
    v_add_f32 v126, 1.0, v126
    v_add_f32 v127, 1.0, v127
    v_rcp_f32 v112, v112
    v_rcp_f32 v113, v113
    v_rcp_f32 v114, v114
    v_rcp_f32 v115, v115
    v_rcp_f32 v116, v116
    v_rcp_f32 v117, v117
    v_rcp_f32 v118, v118
    v_rcp_f32 v119, v119
    v_rcp_f32 v120, v120
    v_rcp_f32 v121, v121
    v_rcp_f32 v122, v122
    v_rcp_f32 v123, v123
    v_rcp_f32 v124, v124
    v_rcp_f32 v125, v125
    v_rcp_f32 v126, v126
    v_rcp_f32 v127, v127
    s_nop 0
    v_pk_fma_f32 v[96:97], v[96:97], v[112:113], v[80:81]
    v_pk_fma_f32 v[98:99], v[98:99], v[114:115], v[82:83]
    v_pk_fma_f32 v[100:101], v[100:101], v[116:117], v[84:85]
    v_pk_fma_f32 v[102:103], v[102:103], v[118:119], v[86:87]
    v_pk_fma_f32 v[104:105], v[104:105], v[120:121], v[88:89]
    v_pk_fma_f32 v[106:107], v[106:107], v[122:123], v[90:91]
    v_pk_fma_f32 v[108:109], v[108:109], v[124:125], v[92:93]
    v_pk_fma_f32 v[110:111], v[110:111], v[126:127], v[94:95]
    v_cvt_pk_bf16_f32 v64, v96, v97
    v_cvt_pk_bf16_f32 v65, v98, v99
    v_cvt_pk_bf16_f32 v66, v100, v101
    v_cvt_pk_bf16_f32 v67, v102, v103
    v_cvt_pk_bf16_f32 v68, v104, v105
    v_cvt_pk_bf16_f32 v69, v106, v107
    v_cvt_pk_bf16_f32 v70, v108, v109
    v_cvt_pk_bf16_f32 v71, v110, v111
    s_nop 1
    v_permlane32_swap_b32 v64, v66
    v_permlane32_swap_b32 v65, v67
    v_permlane32_swap_b32 v68, v70
    v_permlane32_swap_b32 v69, v71
    buffer_store_dwordx4 v[64:67], v5, s[24:27], 0 offen
    buffer_store_dwordx4 v[68:71], v5, s[24:27], 0 offen offset:32
    s_endpgm
L_MTAIL:
    s_waitcnt vmcnt(0)
    s_add_u32 s41, s77, 0
    s_mov_b64 exec, 1
    s_cbranch_vccz L_SA2
    buffer_store_dwordx2 v[120:121], v119, s[32:35], s41 offen
L_SB2:
    s_mov_b64 exec, -1
    s_branch L_MDONE
L_SOFT:
    s_mov_b64 exec, 1
    ds_add_u32 v122, v124
    s_mov_b64 exec, -1
    s_cmp_eq_u32 s56, 6
    s_cbranch_scc0 L_SOFTB
    s_mov_b32 s44, 0
L_SOFT1:
    ds_read_b32 v120, v122 offset:4
    s_add_u32 s44, s44, 1
    s_waitcnt lgkmcnt(0)
    v_readfirstlane_b32 s45, v120
    s_cmp_ge_u32 s44, 524288
    s_cbranch_scc1 L_SOFTB
    s_cmp_lt_u32 s45, 4
    s_cbranch_scc1 L_SOFT1
    s_branch L_SOFTB
L_SA0:
    buffer_store_dwordx2 v[120:121], v119, s[32:35], s41 offen sc1
    s_branch L_SB0
L_SA1:
    buffer_store_dwordx2 v[120:121], v119, s[32:35], s41 offen sc1
    s_branch L_SB1
L_SA2:
    buffer_store_dwordx2 v[120:121], v119, s[32:35], s41 offen sc1
    s_branch L_SB2
L_MMA_DFT:
    s_lshr_b32 s38, s23, 1
    s_and_b32 s39, s23, 1
    s_lshl_b32 s39, s39, 5
    s_add_u32 s38, s38, s39
    s_lshl_b32 s39, s22, 1
    s_add_u32 s38, s38, s39
    s_lshl_b32 s39, s20, 9
    s_add_u32 s38, s38, s39
    s_lshl_b32 s38, s38, 10
    v_lshrrev_b32 v2, 3, v0
    v_and_b32 v3, 7, v0
    v_lshlrev_b32 v4, 16, v2
    v_lshl_add_u32 v4, v3, 4, v4
    v_mov_b32 v5, 0
    buffer_load_dwordx4 v[16:19], v4, s[24:27], s38 offen offset:0
    buffer_load_dwordx4 v[20:23], v4, s[24:27], s38 offen offset:128
    buffer_load_dwordx4 v[24:27], v4, s[24:27], s38 offen offset:256
    buffer_load_dwordx4 v[28:31], v4, s[24:27], s38 offen offset:384
    buffer_load_dwordx4 v[32:35], v4, s[24:27], s38 offen offset:512
    buffer_load_dwordx4 v[36:39], v4, s[24:27], s38 offen offset:640
    buffer_load_dwordx4 v[40:43], v4, s[24:27], s38 offen offset:768
    buffer_load_dwordx4 v[44:47], v4, s[24:27], s38 offen offset:896
    buffer_load_dwordx2 v[6:7], v5, s[88:91], 0 offen sc1
    s_lshl_b32 s53, s22, 2
    s_add_u32 s53, s53, s23
    s_lshl_b32 s53, s53, 7
    s_add_u32 s53, s53, 9469952
    buffer_load_dword v59, v5, s[32:35], s53 offen
    s_getpc_b64 s[44:45]
L_PC:
    s_add_u32 s44, s44, L_CSTAB-L_PC
    s_addc_u32 s45, s45, 0
    s_lshl_b32 s39, s23, 6
    s_lshl_b32 s40, s37, 5
    s_add_u32 s79, s39, s40
    v_and_b32 v1, 31, v0
    v_add_u32 v60, s79, v1
    v_lshlrev_b32 v60, 2, v60
    global_load_dword v62, v60, s[44:45]
    global_load_dword v63, v60, s[44:45] offset:1024
    v_lshrrev_b32 v61, 5, v0
    s_lshl_b32 s78, s22, 1
    s_add_u32 s78, s78, s36
    v_cvt_f32_u32 v56, v1
    v_mul_f32 v56, 0x3a000000, v56
    v_lshlrev_b32 v57, 8, v61
    v_add_u32 v57, s78, v57
    v_cvt_f32_u32 v57, v57
    v_mul_f32 v57, v57, v56
    v_cmp_eq_u32 vcc, 0, v1
    v_fmamk_f32 v48, v56, 0x00000000, v57
    v_fmamk_f32 v49, v56, 0x42800000, v57
    v_cos_f32 v50, v48
    v_cos_f32 v51, v49
    v_sin_f32 v52, v48
    v_sin_f32 v53, v49
    v_cvt_pk_bf16_f32 v64, v50, v51
    v_mov_b32 v54, 0x3f803f80
    v_cvt_pk_bf16_f32 v55, v52, v53
    v_cndmask_b32 v80, v55, v54, vcc
    v_fmamk_f32 v48, v56, 0x43000000, v57
    v_fmamk_f32 v49, v56, 0x43400000, v57
    v_cos_f32 v50, v48
    v_cos_f32 v51, v49
    v_sin_f32 v52, v48
    v_sin_f32 v53, v49
    v_cvt_pk_bf16_f32 v65, v50, v51
    v_mov_b32 v54, 0x3f803f80
    v_cvt_pk_bf16_f32 v55, v52, v53
    v_cndmask_b32 v81, v55, v54, vcc
    v_fmamk_f32 v48, v56, 0x44000000, v57
    v_fmamk_f32 v49, v56, 0x44100000, v57
    v_cos_f32 v50, v48
    v_cos_f32 v51, v49
    v_sin_f32 v52, v48
    v_sin_f32 v53, v49
    v_cvt_pk_bf16_f32 v66, v50, v51
    v_mov_b32 v54, 0x3f803f80
    v_cvt_pk_bf16_f32 v55, v52, v53
    v_cndmask_b32 v82, v55, v54, vcc
    v_fmamk_f32 v48, v56, 0x44200000, v57
    v_fmamk_f32 v49, v56, 0x44300000, v57
    v_cos_f32 v50, v48
    v_cos_f32 v51, v49
    v_sin_f32 v52, v48
    v_sin_f32 v53, v49
    v_cvt_pk_bf16_f32 v67, v50, v51
    v_mov_b32 v54, 0x3f803f80
    v_cvt_pk_bf16_f32 v55, v52, v53
    v_cndmask_b32 v83, v55, v54, vcc
    v_fmamk_f32 v48, v56, 0x44800000, v57
    v_fmamk_f32 v49, v56, 0x44880000, v57
    v_cos_f32 v50, v48
    v_cos_f32 v51, v49
    v_sin_f32 v52, v48
    v_sin_f32 v53, v49
    v_cvt_pk_bf16_f32 v68, v50, v51
    v_mov_b32 v54, 0x3f803f80
    v_cvt_pk_bf16_f32 v55, v52, v53
    v_cndmask_b32 v84, v55, v54, vcc
    v_fmamk_f32 v48, v56, 0x44900000, v57
    v_fmamk_f32 v49, v56, 0x44980000, v57
    v_cos_f32 v50, v48
    v_cos_f32 v51, v49
    v_sin_f32 v52, v48
    v_sin_f32 v53, v49
    v_cvt_pk_bf16_f32 v69, v50, v51
    v_mov_b32 v54, 0x3f803f80
    v_cvt_pk_bf16_f32 v55, v52, v53
    v_cndmask_b32 v85, v55, v54, vcc
    v_fmamk_f32 v48, v56, 0x44c00000, v57
    v_fmamk_f32 v49, v56, 0x44c80000, v57
    v_cos_f32 v50, v48
    v_cos_f32 v51, v49
    v_sin_f32 v52, v48
    v_sin_f32 v53, v49
    v_cvt_pk_bf16_f32 v70, v50, v51
    v_mov_b32 v54, 0x3f803f80
    v_cvt_pk_bf16_f32 v55, v52, v53
    v_cndmask_b32 v86, v55, v54, vcc
    v_fmamk_f32 v48, v56, 0x44d00000, v57
    v_fmamk_f32 v49, v56, 0x44d80000, v57
    v_cos_f32 v50, v48
    v_cos_f32 v51, v49
    v_sin_f32 v52, v48
    v_sin_f32 v53, v49
    v_cvt_pk_bf16_f32 v71, v50, v51
    v_mov_b32 v54, 0x3f803f80
    v_cvt_pk_bf16_f32 v55, v52, v53
    v_cndmask_b32 v87, v55, v54, vcc
    v_fmamk_f32 v48, v56, 0x42000000, v57
    v_fmamk_f32 v49, v56, 0x42c00000, v57
    v_cos_f32 v50, v48
    v_cos_f32 v51, v49
    v_sin_f32 v52, v48
    v_sin_f32 v53, v49
    v_cvt_pk_bf16_f32 v72, v50, v51
    v_mov_b32 v54, 0xbf80bf80
    v_cvt_pk_bf16_f32 v55, v52, v53
    v_cndmask_b32 v88, v55, v54, vcc
    v_fmamk_f32 v48, v56, 0x43200000, v57
    v_fmamk_f32 v49, v56, 0x43600000, v57
    v_cos_f32 v50, v48
    v_cos_f32 v51, v49
    v_sin_f32 v52, v48
    v_sin_f32 v53, v49
    v_cvt_pk_bf16_f32 v73, v50, v51
    v_mov_b32 v54, 0xbf80bf80
    v_cvt_pk_bf16_f32 v55, v52, v53
    v_cndmask_b32 v89, v55, v54, vcc
    v_fmamk_f32 v48, v56, 0x44080000, v57
    v_fmamk_f32 v49, v56, 0x44180000, v57
    v_cos_f32 v50, v48
    v_cos_f32 v51, v49
    v_sin_f32 v52, v48
    v_sin_f32 v53, v49
    v_cvt_pk_bf16_f32 v74, v50, v51
    v_mov_b32 v54, 0xbf80bf80
    v_cvt_pk_bf16_f32 v55, v52, v53
    v_cndmask_b32 v90, v55, v54, vcc
    v_fmamk_f32 v48, v56, 0x44280000, v57
    v_fmamk_f32 v49, v56, 0x44380000, v57
    v_cos_f32 v50, v48
    v_cos_f32 v51, v49
    v_sin_f32 v52, v48
    v_sin_f32 v53, v49
    v_cvt_pk_bf16_f32 v75, v50, v51
    v_mov_b32 v54, 0xbf80bf80
    v_cvt_pk_bf16_f32 v55, v52, v53
    v_cndmask_b32 v91, v55, v54, vcc
    v_fmamk_f32 v48, v56, 0x44840000, v57
    v_fmamk_f32 v49, v56, 0x448c0000, v57
    v_cos_f32 v50, v48
    v_cos_f32 v51, v49
    v_sin_f32 v52, v48
    v_sin_f32 v53, v49
    v_cvt_pk_bf16_f32 v76, v50, v51
    v_mov_b32 v54, 0xbf80bf80
    v_cvt_pk_bf16_f32 v55, v52, v53
    v_cndmask_b32 v92, v55, v54, vcc
    v_fmamk_f32 v48, v56, 0x44940000, v57
    v_fmamk_f32 v49, v56, 0x449c0000, v57
    v_cos_f32 v50, v48
    v_cos_f32 v51, v49
    v_sin_f32 v52, v48
    v_sin_f32 v53, v49
    v_cvt_pk_bf16_f32 v77, v50, v51
    v_mov_b32 v54, 0xbf80bf80
    v_cvt_pk_bf16_f32 v55, v52, v53
    v_cndmask_b32 v93, v55, v54, vcc
    v_fmamk_f32 v48, v56, 0x44c40000, v57
    v_fmamk_f32 v49, v56, 0x44cc0000, v57
    v_cos_f32 v50, v48
    v_cos_f32 v51, v49
    v_sin_f32 v52, v48
    v_sin_f32 v53, v49
    v_cvt_pk_bf16_f32 v78, v50, v51
    v_mov_b32 v54, 0xbf80bf80
    v_cvt_pk_bf16_f32 v55, v52, v53
    v_cndmask_b32 v94, v55, v54, vcc
    v_fmamk_f32 v48, v56, 0x44d40000, v57
    v_fmamk_f32 v49, v56, 0x44dc0000, v57
    v_cos_f32 v50, v48
    v_cos_f32 v51, v49
    v_sin_f32 v52, v48
    v_sin_f32 v53, v49
    v_cvt_pk_bf16_f32 v79, v50, v51
    v_mov_b32 v54, 0xbf80bf80
    v_cvt_pk_bf16_f32 v55, v52, v53
    v_cndmask_b32 v95, v55, v54, vcc
    v_mov_b32 v128, 0
    v_mov_b32 v129, 0
    v_mov_b32 v130, 0
    v_mov_b32 v131, 0
    v_mov_b32 v132, 0
    v_mov_b32 v133, 0
    v_mov_b32 v134, 0
    v_mov_b32 v135, 0
    v_mov_b32 v136, 0
    v_mov_b32 v137, 0
    v_mov_b32 v138, 0
    v_mov_b32 v139, 0
    v_mov_b32 v140, 0
    v_mov_b32 v141, 0
    v_mov_b32 v142, 0
    v_mov_b32 v143, 0
    v_mov_b32 v144, 0
    v_mov_b32 v145, 0
    v_mov_b32 v146, 0
    v_mov_b32 v147, 0
    v_mov_b32 v148, 0
    v_mov_b32 v149, 0
    v_mov_b32 v150, 0
    v_mov_b32 v151, 0
    v_mov_b32 v152, 0
    v_mov_b32 v153, 0
    v_mov_b32 v154, 0
    v_mov_b32 v155, 0
    v_mov_b32 v156, 0
    v_mov_b32 v157, 0
    v_mov_b32 v158, 0
    v_mov_b32 v159, 0
    v_mov_b32 v160, 0
    v_mov_b32 v161, 0
    v_mov_b32 v162, 0
    v_mov_b32 v163, 0
    v_mov_b32 v164, 0
    v_mov_b32 v165, 0
    v_mov_b32 v166, 0
    v_mov_b32 v167, 0
    v_mov_b32 v168, 0
    v_mov_b32 v169, 0
    v_mov_b32 v170, 0
    v_mov_b32 v171, 0
    v_mov_b32 v172, 0
    v_mov_b32 v173, 0
    v_mov_b32 v174, 0
    v_mov_b32 v175, 0
    v_mov_b32 v176, 0
    v_mov_b32 v177, 0
    v_mov_b32 v178, 0
    v_mov_b32 v179, 0
    v_mov_b32 v180, 0
    v_mov_b32 v181, 0
    v_mov_b32 v182, 0
    v_mov_b32 v183, 0
    v_mov_b32 v184, 0
    v_mov_b32 v185, 0
    v_mov_b32 v186, 0
    v_mov_b32 v187, 0
    v_mov_b32 v188, 0
    v_mov_b32 v189, 0
    v_mov_b32 v190, 0
    v_mov_b32 v191, 0
    s_mov_b32 s48, 0xffff0000
    v_mov_b32 v48, 0
    v_mov_b32 v49, 0
    v_mov_b32 v50, 0
    v_mov_b32 v51, 0
    s_waitcnt vmcnt(11)
    v_and_b32 v52, s48, v16
    v_lshlrev_b32 v53, 16, v16
    v_add_f32 v48, v48, v52
    v_add_f32 v49, v49, v53
    v_fmac_f32 v50, v52, v52
    v_fmac_f32 v51, v53, v53
    v_and_b32 v52, s48, v17
    v_lshlrev_b32 v53, 16, v17
    v_add_f32 v48, v48, v52
    v_add_f32 v49, v49, v53
    v_fmac_f32 v50, v52, v52
    v_fmac_f32 v51, v53, v53
    v_and_b32 v52, s48, v18
    v_lshlrev_b32 v53, 16, v18
    v_add_f32 v48, v48, v52
    v_add_f32 v49, v49, v53
    v_fmac_f32 v50, v52, v52
    v_fmac_f32 v51, v53, v53
    v_and_b32 v52, s48, v19
    v_lshlrev_b32 v53, 16, v19
    v_add_f32 v48, v48, v52
    v_add_f32 v49, v49, v53
    v_fmac_f32 v50, v52, v52
    v_fmac_f32 v51, v53, v53
    s_waitcnt vmcnt(10)
    v_and_b32 v52, s48, v20
    v_lshlrev_b32 v53, 16, v20
    v_add_f32 v48, v48, v52
    v_add_f32 v49, v49, v53
    v_fmac_f32 v50, v52, v52
    v_fmac_f32 v51, v53, v53
    v_and_b32 v52, s48, v21
    v_lshlrev_b32 v53, 16, v21
    v_add_f32 v48, v48, v52
    v_add_f32 v49, v49, v53
    v_fmac_f32 v50, v52, v52
    v_fmac_f32 v51, v53, v53
    v_and_b32 v52, s48, v22
    v_lshlrev_b32 v53, 16, v22
    v_add_f32 v48, v48, v52
    v_add_f32 v49, v49, v53
    v_fmac_f32 v50, v52, v52
    v_fmac_f32 v51, v53, v53
    v_and_b32 v52, s48, v23
    v_lshlrev_b32 v53, 16, v23
    v_add_f32 v48, v48, v52
    v_add_f32 v49, v49, v53
    v_fmac_f32 v50, v52, v52
    v_fmac_f32 v51, v53, v53
    s_waitcnt vmcnt(9)
    v_and_b32 v52, s48, v24
    v_lshlrev_b32 v53, 16, v24
    v_add_f32 v48, v48, v52
    v_add_f32 v49, v49, v53
    v_fmac_f32 v50, v52, v52
    v_fmac_f32 v51, v53, v53
    v_and_b32 v52, s48, v25
    v_lshlrev_b32 v53, 16, v25
    v_add_f32 v48, v48, v52
    v_add_f32 v49, v49, v53
    v_fmac_f32 v50, v52, v52
    v_fmac_f32 v51, v53, v53
    v_and_b32 v52, s48, v26
    v_lshlrev_b32 v53, 16, v26
    v_add_f32 v48, v48, v52
    v_add_f32 v49, v49, v53
    v_fmac_f32 v50, v52, v52
    v_fmac_f32 v51, v53, v53
    v_and_b32 v52, s48, v27
    v_lshlrev_b32 v53, 16, v27
    v_add_f32 v48, v48, v52
    v_add_f32 v49, v49, v53
    v_fmac_f32 v50, v52, v52
    v_fmac_f32 v51, v53, v53
    s_waitcnt vmcnt(8)
    v_and_b32 v52, s48, v28
    v_lshlrev_b32 v53, 16, v28
    v_add_f32 v48, v48, v52
    v_add_f32 v49, v49, v53
    v_fmac_f32 v50, v52, v52
    v_fmac_f32 v51, v53, v53
    v_and_b32 v52, s48, v29
    v_lshlrev_b32 v53, 16, v29
    v_add_f32 v48, v48, v52
    v_add_f32 v49, v49, v53
    v_fmac_f32 v50, v52, v52
    v_fmac_f32 v51, v53, v53
    v_and_b32 v52, s48, v30
    v_lshlrev_b32 v53, 16, v30
    v_add_f32 v48, v48, v52
    v_add_f32 v49, v49, v53
    v_fmac_f32 v50, v52, v52
    v_fmac_f32 v51, v53, v53
    v_and_b32 v52, s48, v31
    v_lshlrev_b32 v53, 16, v31
    v_add_f32 v48, v48, v52
    v_add_f32 v49, v49, v53
    v_fmac_f32 v50, v52, v52
    v_fmac_f32 v51, v53, v53
    s_waitcnt vmcnt(7)
    v_and_b32 v52, s48, v32
    v_lshlrev_b32 v53, 16, v32
    v_add_f32 v48, v48, v52
    v_add_f32 v49, v49, v53
    v_fmac_f32 v50, v52, v52
    v_fmac_f32 v51, v53, v53
    v_and_b32 v52, s48, v33
    v_lshlrev_b32 v53, 16, v33
    v_add_f32 v48, v48, v52
    v_add_f32 v49, v49, v53
    v_fmac_f32 v50, v52, v52
    v_fmac_f32 v51, v53, v53
    v_and_b32 v52, s48, v34
    v_lshlrev_b32 v53, 16, v34
    v_add_f32 v48, v48, v52
    v_add_f32 v49, v49, v53
    v_fmac_f32 v50, v52, v52
    v_fmac_f32 v51, v53, v53
    v_and_b32 v52, s48, v35
    v_lshlrev_b32 v53, 16, v35
    v_add_f32 v48, v48, v52
    v_add_f32 v49, v49, v53
    v_fmac_f32 v50, v52, v52
    v_fmac_f32 v51, v53, v53
    s_waitcnt vmcnt(6)
    v_and_b32 v52, s48, v36
    v_lshlrev_b32 v53, 16, v36
    v_add_f32 v48, v48, v52
    v_add_f32 v49, v49, v53
    v_fmac_f32 v50, v52, v52
    v_fmac_f32 v51, v53, v53
    v_and_b32 v52, s48, v37
    v_lshlrev_b32 v53, 16, v37
    v_add_f32 v48, v48, v52
    v_add_f32 v49, v49, v53
    v_fmac_f32 v50, v52, v52
    v_fmac_f32 v51, v53, v53
    v_and_b32 v52, s48, v38
    v_lshlrev_b32 v53, 16, v38
    v_add_f32 v48, v48, v52
    v_add_f32 v49, v49, v53
    v_fmac_f32 v50, v52, v52
    v_fmac_f32 v51, v53, v53
    v_and_b32 v52, s48, v39
    v_lshlrev_b32 v53, 16, v39
    v_add_f32 v48, v48, v52
    v_add_f32 v49, v49, v53
    v_fmac_f32 v50, v52, v52
    v_fmac_f32 v51, v53, v53
    s_waitcnt vmcnt(5)
    v_and_b32 v52, s48, v40
    v_lshlrev_b32 v53, 16, v40
    v_add_f32 v48, v48, v52
    v_add_f32 v49, v49, v53
    v_fmac_f32 v50, v52, v52
    v_fmac_f32 v51, v53, v53
    v_and_b32 v52, s48, v41
    v_lshlrev_b32 v53, 16, v41
    v_add_f32 v48, v48, v52
    v_add_f32 v49, v49, v53
    v_fmac_f32 v50, v52, v52
    v_fmac_f32 v51, v53, v53
    v_and_b32 v52, s48, v42
    v_lshlrev_b32 v53, 16, v42
    v_add_f32 v48, v48, v52
    v_add_f32 v49, v49, v53
    v_fmac_f32 v50, v52, v52
    v_fmac_f32 v51, v53, v53
    v_and_b32 v52, s48, v43
    v_lshlrev_b32 v53, 16, v43
    v_add_f32 v48, v48, v52
    v_add_f32 v49, v49, v53
    v_fmac_f32 v50, v52, v52
    v_fmac_f32 v51, v53, v53
    s_waitcnt vmcnt(4)
    v_and_b32 v52, s48, v44
    v_lshlrev_b32 v53, 16, v44
    v_add_f32 v48, v48, v52
    v_add_f32 v49, v49, v53
    v_fmac_f32 v50, v52, v52
    v_fmac_f32 v51, v53, v53
    v_and_b32 v52, s48, v45
    v_lshlrev_b32 v53, 16, v45
    v_add_f32 v48, v48, v52
    v_add_f32 v49, v49, v53
    v_fmac_f32 v50, v52, v52
    v_fmac_f32 v51, v53, v53
    v_and_b32 v52, s48, v46
    v_lshlrev_b32 v53, 16, v46
    v_add_f32 v48, v48, v52
    v_add_f32 v49, v49, v53
    v_fmac_f32 v50, v52, v52
    v_fmac_f32 v51, v53, v53
    v_and_b32 v52, s48, v47
    v_lshlrev_b32 v53, 16, v47
    v_add_f32 v48, v48, v52
    v_add_f32 v49, v49, v53
    v_fmac_f32 v50, v52, v52
    v_fmac_f32 v51, v53, v53
    v_add_f32 v48, v48, v49
    v_add_f32 v50, v50, v51
    s_nop 1
    v_add_f32_dpp v48, v48, v48 quad_perm:[1,0,3,2] row_mask:0xf bank_mask:0xf
    v_add_f32_dpp v50, v50, v50 quad_perm:[1,0,3,2] row_mask:0xf bank_mask:0xf
    s_nop 1
    v_add_f32_dpp v48, v48, v48 quad_perm:[2,3,0,1] row_mask:0xf bank_mask:0xf
    v_add_f32_dpp v50, v50, v50 quad_perm:[2,3,0,1] row_mask:0xf bank_mask:0xf
    s_nop 1
    v_add_f32_dpp v48, v48, v48 row_half_mirror row_mask:0xf bank_mask:0xf
    v_add_f32_dpp v50, v50, v50 row_half_mirror row_mask:0xf bank_mask:0xf
    v_mul_f32 v48, 0x3b000000, v48
    v_mul_f32 v50, 0x3b000000, v50
    v_fma_f32 v50, -v48, v48, v50
    v_max_f32 v50, 0, v50
    v_cvt_pk_bf16_f32 v52, -v48, v50
    v_lshlrev_b32 v16, 16, v52
    v_and_b32 v50, s48, v52
    v_add_f32 v50, 0x3727c5ac, v50
    v_cvt_pk_bf16_f32 v50, v50, v50
    v_and_b32 v50, s48, v50
    v_sqrt_f32 v50, v50
    s_lshl_b32 s38, s22, 7
    s_lshl_b32 s39, s23, 5
    s_add_u32 s38, s38, s39
    s_lshl_b32 s39, s20, 3
    s_add_u32 s38, s38, s39
    s_lshl_b32 s38, s38, 4
    s_add_u32 s38, s38, 9437184
    v_cvt_pk_bf16_f32 v50, v50, v50
    v_and_b32 v17, s48, v50
    v_lshlrev_b32 v4, 4, v2
    s_mov_b32 s56, 0
    s_waitcnt vmcnt(0)
L_DN:
    v_readfirstlane_b32 s92, v6
    s_add_u32 s56, s56, 1
    s_cmp_ge_u32 s56, 32768
    s_cbranch_scc1 L_DN_OK
    s_cmp_eq_u32 s92, 0
    s_cbranch_scc1 L_DN_RE
    s_memrealtime s[40:41]
    s_waitcnt lgkmcnt(0)
    s_sub_u32 s41, s40, s92
    s_cmp_lt_i32 s41, 800
    s_cbranch_scc1 L_DN_OK
    s_cmp_ge_u32 s56, 40
    s_cbranch_scc1 L_DN_OK
L_DN_RE:
    buffer_load_dwordx2 v[6:7], v5, s[88:91], 0 offen sc1
    s_waitcnt vmcnt(0)
    s_branch L_DN
L_DN_OK:
    v_mov_b32 v18, v6
    v_mov_b32 v19, v7
    s_mov_b32 exec_lo, 0x01010101
    s_mov_b32 exec_hi, 0x01010101
    buffer_store_dwordx4 v[16:19], v4, s[32:35], s38 offen sc1
    s_mov_b64 exec, -1
    v_readfirstlane_b32 s93, v7
    v_bfe_u32 v3, v0, 1, 3
    v_xor_b32 v3, v3, v61
    v_lshlrev_b32 v3, 4, v3
    v_lshl_add_u32 v3, v1, 7, v3
    s_lshl_b32 s38, s36, 13
    v_add_u32 v8, s38, v3
    s_lshl_b32 s38, s37, 12
    s_add_u32 s38, s38, 49152
    v_add_u32 v12, s38, v3
    v_xor_b32 v9, 32, v8
    v_xor_b32 v13, 32, v12
    v_xor_b32 v10, 64, v8
    v_xor_b32 v14, 64, v12
    v_xor_b32 v11, 96, v8
    v_xor_b32 v15, 96, v12
    s_mov_b32 s56, 0
    s_mov_b32 s57, 0
    s_barrier
    ds_read_b128 v[16:19], v8
    ds_read_b128 v[24:27], v12
    ds_read_b128 v[28:31], v12 offset:8192
    ds_read_b128 v[20:23], v8 offset:4096
    ds_read_b128 v[32:35], v9
    ds_read_b128 v[40:43], v13
    ds_read_b128 v[44:47], v13 offset:8192
    ds_read_b128 v[36:39], v9 offset:4096
    .p2align 3
L_DLOOP:
    s_waitcnt lgkmcnt(4)
    v_mfma_f32_32x32x16_bf16 v[128:143], v[16:19], v[24:27], v[128:143]
    ds_read_b128 v[96:99], v10
    s_add_u32 s57, s57, 1
    s_cmp_eq_u32 s57, 3
    s_cselect_b32 s58, -2, 1
    v_mfma_f32_32x32x16_bf16 v[144:159], v[16:19], v[28:31], v[144:159]
    ds_read_b128 v[104:107], v14
    s_cselect_b32 s57, 0, s57
    s_lshl_b32 s58, s58, 14
    v_mfma_f32_32x32x16_bf16 v[160:175], v[20:23], v[24:27], v[160:175]
    ds_read_b128 v[108:111], v14 offset:8192
    v_add_u32 v8, s58, v8
    v_add_u32 v12, s58, v12
    v_mfma_f32_32x32x16_bf16 v[176:191], v[20:23], v[28:31], v[176:191]
    ds_read_b128 v[100:103], v10 offset:4096
    v_add_u32 v9, s58, v9
    v_add_u32 v13, s58, v13
    s_waitcnt lgkmcnt(4)
    v_mfma_f32_32x32x16_bf16 v[128:143], v[32:35], v[40:43], v[128:143]
    ds_read_b128 v[112:115], v11
    v_mfma_f32_32x32x16_bf16 v[144:159], v[32:35], v[44:47], v[144:159]
    ds_read_b128 v[120:123], v15
    v_mfma_f32_32x32x16_bf16 v[160:175], v[36:39], v[40:43], v[160:175]
    ds_read_b128 v[124:127], v15 offset:8192
    v_mfma_f32_32x32x16_bf16 v[176:191], v[36:39], v[44:47], v[176:191]
    ds_read_b128 v[116:119], v11 offset:4096
    s_waitcnt lgkmcnt(4)
    v_mfma_f32_32x32x16_bf16 v[128:143], v[96:99], v[104:107], v[128:143]
    s_waitcnt lgkmcnt(0)
    s_barrier
    v_mfma_f32_32x32x16_bf16 v[144:159], v[96:99], v[108:111], v[144:159]
    ds_read_b128 v[16:19], v8
    ds_read_b128 v[24:27], v12
    v_mfma_f32_32x32x16_bf16 v[160:175], v[100:103], v[104:107], v[160:175]
    ds_read_b128 v[28:31], v12 offset:8192
    v_add_u32 v10, s58, v10
    v_add_u32 v14, s58, v14
    v_mfma_f32_32x32x16_bf16 v[176:191], v[100:103], v[108:111], v[176:191]
    ds_read_b128 v[20:23], v8 offset:4096
    v_add_u32 v11, s58, v11
    v_add_u32 v15, s58, v15
    v_mfma_f32_32x32x16_bf16 v[128:143], v[112:115], v[120:123], v[128:143]
    ds_read_b128 v[32:35], v9
    v_mfma_f32_32x32x16_bf16 v[144:159], v[112:115], v[124:127], v[144:159]
    ds_read_b128 v[40:43], v13
    v_mfma_f32_32x32x16_bf16 v[160:175], v[116:119], v[120:123], v[160:175]
    ds_read_b128 v[44:47], v13 offset:8192
    s_add_u32 s56, s56, 1
    s_cmp_lt_u32 s56, 8
    v_mfma_f32_32x32x16_bf16 v[176:191], v[116:119], v[124:127], v[176:191]
    ds_read_b128 v[36:39], v9 offset:4096
    s_cbranch_scc1 L_DLOOP
    s_waitcnt lgkmcnt(0)
    s_lshl_b32 s39, s36, 8
    s_add_u32 s39, s39, 159744
    v_lshlrev_b32 v3, 4, v61
    v_add_u32 v3, s39, v3
    v_mov_b32 v4, v62
    v_mov_b32 v5, v62
    v_mov_b32 v6, v63
    v_mov_b32 v7, v63
    v_cmp_eq_u32 vcc, 0, v1
    ds_read_b128 v[16:19], v3 offset:0
    ds_read_b128 v[20:23], v3 offset:32
    ds_read_b128 v[24:27], v3 offset:64
    ds_read_b128 v[28:31], v3 offset:96
    ds_read_b128 v[32:35], v3 offset:512
    ds_read_b128 v[36:39], v3 offset:544
    ds_read_b128 v[40:43], v3 offset:576
    ds_read_b128 v[44:47], v3 offset:608
    s_waitcnt lgkmcnt(0)
    v_pk_fma_f32 v[128:129], v[16:17], v[4:5], v[128:129]
    v_pk_fma_f32 v[130:131], v[18:19], v[4:5], v[130:131]
    v_pk_fma_f32 v[132:133], v[20:21], v[4:5], v[132:133]
    v_pk_fma_f32 v[134:135], v[22:23], v[4:5], v[134:135]
    v_pk_fma_f32 v[136:137], v[24:25], v[4:5], v[136:137]
    v_pk_fma_f32 v[138:139], v[26:27], v[4:5], v[138:139]
    v_pk_fma_f32 v[140:141], v[28:29], v[4:5], v[140:141]
    v_pk_fma_f32 v[142:143], v[30:31], v[4:5], v[142:143]
    v_pk_mul_f32 v[128:129], v[128:129], v[32:33]
    v_pk_mul_f32 v[130:131], v[130:131], v[34:35]
    v_pk_mul_f32 v[132:133], v[132:133], v[36:37]
    v_pk_mul_f32 v[134:135], v[134:135], v[38:39]
    v_pk_mul_f32 v[136:137], v[136:137], v[40:41]
    v_pk_mul_f32 v[138:139], v[138:139], v[42:43]
    v_pk_mul_f32 v[140:141], v[140:141], v[44:45]
    v_pk_mul_f32 v[142:143], v[142:143], v[46:47]
    v_cvt_pk_bf16_f32 v96, v128, v129
    v_cvt_pk_bf16_f32 v97, v130, v131
    v_cvt_pk_bf16_f32 v98, v132, v133
    v_cvt_pk_bf16_f32 v99, v134, v135
    v_cvt_pk_bf16_f32 v100, v136, v137
    v_cvt_pk_bf16_f32 v101, v138, v139
    v_cvt_pk_bf16_f32 v102, v140, v141
    v_cvt_pk_bf16_f32 v103, v142, v143
    v_pk_fma_f32 v[144:145], v[16:17], v[6:7], v[144:145]
    v_pk_fma_f32 v[146:147], v[18:19], v[6:7], v[146:147]
    v_pk_fma_f32 v[148:149], v[20:21], v[6:7], v[148:149]
    v_pk_fma_f32 v[150:151], v[22:23], v[6:7], v[150:151]
    v_pk_fma_f32 v[152:153], v[24:25], v[6:7], v[152:153]
    v_pk_fma_f32 v[154:155], v[26:27], v[6:7], v[154:155]
    v_pk_fma_f32 v[156:157], v[28:29], v[6:7], v[156:157]
    v_pk_fma_f32 v[158:159], v[30:31], v[6:7], v[158:159]
    v_pk_mul_f32 v[144:145], v[144:145], v[32:33]
    v_pk_mul_f32 v[146:147], v[146:147], v[34:35]
    v_pk_mul_f32 v[148:149], v[148:149], v[36:37]
    v_pk_mul_f32 v[150:151], v[150:151], v[38:39]
    v_pk_mul_f32 v[152:153], v[152:153], v[40:41]
    v_pk_mul_f32 v[154:155], v[154:155], v[42:43]
    v_pk_mul_f32 v[156:157], v[156:157], v[44:45]
    v_pk_mul_f32 v[158:159], v[158:159], v[46:47]
    v_cvt_pk_bf16_f32 v112, v144, v145
    v_cvt_pk_bf16_f32 v113, v146, v147
    v_cvt_pk_bf16_f32 v114, v148, v149
    v_cvt_pk_bf16_f32 v115, v150, v151
    v_cvt_pk_bf16_f32 v116, v152, v153
    v_cvt_pk_bf16_f32 v117, v154, v155
    v_cvt_pk_bf16_f32 v118, v156, v157
    v_cvt_pk_bf16_f32 v119, v158, v159
    ds_read_b128 v[16:19], v3 offset:128
    ds_read_b128 v[20:23], v3 offset:160
    ds_read_b128 v[24:27], v3 offset:192
    ds_read_b128 v[28:31], v3 offset:224
    ds_read_b128 v[32:35], v3 offset:640
    ds_read_b128 v[36:39], v3 offset:672
    ds_read_b128 v[40:43], v3 offset:704
    ds_read_b128 v[44:47], v3 offset:736
    s_waitcnt lgkmcnt(0)
    v_pk_fma_f32 v[160:161], v[16:17], v[4:5], v[160:161]
    v_pk_fma_f32 v[162:163], v[18:19], v[4:5], v[162:163]
    v_pk_fma_f32 v[164:165], v[20:21], v[4:5], v[164:165]
    v_pk_fma_f32 v[166:167], v[22:23], v[4:5], v[166:167]
    v_pk_fma_f32 v[168:169], v[24:25], v[4:5], v[168:169]
    v_pk_fma_f32 v[170:171], v[26:27], v[4:5], v[170:171]
    v_pk_fma_f32 v[172:173], v[28:29], v[4:5], v[172:173]
    v_pk_fma_f32 v[174:175], v[30:31], v[4:5], v[174:175]
    v_pk_mul_f32 v[160:161], v[160:161], v[32:33]
    v_pk_mul_f32 v[162:163], v[162:163], v[34:35]
    v_pk_mul_f32 v[164:165], v[164:165], v[36:37]
    v_pk_mul_f32 v[166:167], v[166:167], v[38:39]
    v_pk_mul_f32 v[168:169], v[168:169], v[40:41]
    v_pk_mul_f32 v[170:171], v[170:171], v[42:43]
    v_pk_mul_f32 v[172:173], v[172:173], v[44:45]
    v_pk_mul_f32 v[174:175], v[174:175], v[46:47]
    v_cvt_pk_bf16_f32 v104, v160, v161
    v_cvt_pk_bf16_f32 v105, v162, v163
    v_cvt_pk_bf16_f32 v106, v164, v165
    v_cvt_pk_bf16_f32 v107, v166, v167
    v_cvt_pk_bf16_f32 v108, v168, v169
    v_cvt_pk_bf16_f32 v109, v170, v171
    v_cvt_pk_bf16_f32 v110, v172, v173
    v_cvt_pk_bf16_f32 v111, v174, v175
    v_pk_fma_f32 v[176:177], v[16:17], v[6:7], v[176:177]
    v_pk_fma_f32 v[178:179], v[18:19], v[6:7], v[178:179]
    v_pk_fma_f32 v[180:181], v[20:21], v[6:7], v[180:181]
    v_pk_fma_f32 v[182:183], v[22:23], v[6:7], v[182:183]
    v_pk_fma_f32 v[184:185], v[24:25], v[6:7], v[184:185]
    v_pk_fma_f32 v[186:187], v[26:27], v[6:7], v[186:187]
    v_pk_fma_f32 v[188:189], v[28:29], v[6:7], v[188:189]
    v_pk_fma_f32 v[190:191], v[30:31], v[6:7], v[190:191]
    v_pk_mul_f32 v[176:177], v[176:177], v[32:33]
    v_pk_mul_f32 v[178:179], v[178:179], v[34:35]
    v_pk_mul_f32 v[180:181], v[180:181], v[36:37]
    v_pk_mul_f32 v[182:183], v[182:183], v[38:39]
    v_pk_mul_f32 v[184:185], v[184:185], v[40:41]
    v_pk_mul_f32 v[186:187], v[186:187], v[42:43]
    v_pk_mul_f32 v[188:189], v[188:189], v[44:45]
    v_pk_mul_f32 v[190:191], v[190:191], v[46:47]
    v_cvt_pk_bf16_f32 v120, v176, v177
    v_cvt_pk_bf16_f32 v121, v178, v179
    v_cvt_pk_bf16_f32 v122, v180, v181
    v_cvt_pk_bf16_f32 v123, v182, v183
    v_cvt_pk_bf16_f32 v124, v184, v185
    v_cvt_pk_bf16_f32 v125, v186, v187
    v_cvt_pk_bf16_f32 v126, v188, v189
    v_cvt_pk_bf16_f32 v127, v190, v191
    s_nop 1
    v_mfma_f32_32x32x16_bf16 v[192:207], v[64:67], v[96:99], 0
    v_mfma_f32_32x32x16_bf16 v[208:223], v[64:67], v[112:115], 0
    v_mfma_f32_32x32x16_bf16 v[224:239], v[80:83], v[96:99], 0
    v_mfma_f32_32x32x16_bf16 v[240:255], v[80:83], v[112:115], 0
    v_mfma_f32_32x32x16_bf16 v[192:207], v[68:71], v[100:103], v[192:207]
    v_mfma_f32_32x32x16_bf16 v[208:223], v[68:71], v[116:119], v[208:223]
    v_mfma_f32_32x32x16_bf16 v[224:239], v[84:87], v[100:103], v[224:239]
    v_mfma_f32_32x32x16_bf16 v[240:255], v[84:87], v[116:119], v[240:255]
    v_mfma_f32_32x32x16_bf16 v[192:207], v[72:75], v[104:107], v[192:207]
    v_mfma_f32_32x32x16_bf16 v[208:223], v[72:75], v[120:123], v[208:223]
    v_mfma_f32_32x32x16_bf16 v[224:239], v[88:91], v[104:107], v[224:239]
    v_mfma_f32_32x32x16_bf16 v[240:255], v[88:91], v[120:123], v[240:255]
    v_mfma_f32_32x32x16_bf16 v[192:207], v[76:79], v[108:111], v[192:207]
    v_mfma_f32_32x32x16_bf16 v[208:223], v[76:79], v[124:127], v[208:223]
    v_mfma_f32_32x32x16_bf16 v[224:239], v[92:95], v[108:111], v[224:239]
    v_mfma_f32_32x32x16_bf16 v[240:255], v[92:95], v[124:127], v[240:255]
    v_add_u32 v8, s79, v1
    v_cmp_eq_u32 vcc, 0, v8
    v_mov_b32 v11, -1
    v_and_b32 v12, 0xfffffffc, v8
    v_and_b32 v10, 3, v0
    v_cndmask_b32_e64 v11, v11, 0, vcc
    v_lshl_add_u32 v10, v61, 2, v10
    v_lshlrev_b32 v10, 11, v10
    v_lshl_add_u32 v12, v12, 2, v10
    v_lshlrev_b32 v8, 2, v8
    v_cvt_f32_u32 v10, v61
    s_mul_i32 s38, s78, 67584
    s_add_u32 s38, s38, 6291456
    s_add_u32 s39, s38, 65536
    s_mov_b32 s44, 0x55555555
    s_mov_b32 s45, s44
    s_mov_b32 s46, 0x33333333
    s_mov_b32 s47, s46
    v_cvt_pk_bf16_f32 v14, v224, v240
    v_cvt_pk_bf16_f32 v15, v224, -v240
    v_mul_f32 v224, v224, v10
    v_mul_f32 v240, v240, v10
    v_and_b32 v14, v14, v11
    s_mov_b32 exec_hi, 0
    buffer_store_dword v14, v8, s[32:35], s39 offen sc1
    buffer_store_dword v15, v8, s[32:35], s39 offen offset:1024 sc1
    s_mov_b64 exec, -1
    v_pk_add_f32 v[48:49], v[192:193], v[240:241]
    v_pk_add_f32 v[50:51], v[208:209], v[224:225] neg_lo:[0,1] neg_hi:[0,1]
    v_pk_add_f32 v[52:53], v[192:193], v[240:241] neg_lo:[0,1] neg_hi:[0,1]
    v_pk_add_f32 v[54:55], v[208:209], v[224:225] neg_lo:[1,1] neg_hi:[1,1]
    v_cvt_pk_bf16_f32 v16, v48, v50
    v_cvt_pk_bf16_f32 v17, v49, v51
    v_cvt_pk_bf16_f32 v32, v52, v54
    v_cvt_pk_bf16_f32 v33, v53, v55
    v_pk_add_f32 v[48:49], v[194:195], v[242:243]
    v_pk_add_f32 v[50:51], v[210:211], v[226:227] neg_lo:[0,1] neg_hi:[0,1]
    v_pk_add_f32 v[52:53], v[194:195], v[242:243] neg_lo:[0,1] neg_hi:[0,1]
    v_pk_add_f32 v[54:55], v[210:211], v[226:227] neg_lo:[1,1] neg_hi:[1,1]
    v_cvt_pk_bf16_f32 v18, v48, v50
    v_cvt_pk_bf16_f32 v19, v49, v51
    v_cvt_pk_bf16_f32 v34, v52, v54
    v_cvt_pk_bf16_f32 v35, v53, v55
    v_pk_add_f32 v[48:49], v[196:197], v[244:245]
    v_pk_add_f32 v[50:51], v[212:213], v[228:229] neg_lo:[0,1] neg_hi:[0,1]
    v_pk_add_f32 v[52:53], v[196:197], v[244:245] neg_lo:[0,1] neg_hi:[0,1]
    v_pk_add_f32 v[54:55], v[212:213], v[228:229] neg_lo:[1,1] neg_hi:[1,1]
    v_cvt_pk_bf16_f32 v20, v48, v50
    v_cvt_pk_bf16_f32 v21, v49, v51
    v_cvt_pk_bf16_f32 v36, v52, v54
    v_cvt_pk_bf16_f32 v37, v53, v55
    v_pk_add_f32 v[48:49], v[198:199], v[246:247]
    v_pk_add_f32 v[50:51], v[214:215], v[230:231] neg_lo:[0,1] neg_hi:[0,1]
    v_pk_add_f32 v[52:53], v[198:199], v[246:247] neg_lo:[0,1] neg_hi:[0,1]
    v_pk_add_f32 v[54:55], v[214:215], v[230:231] neg_lo:[1,1] neg_hi:[1,1]
    v_cvt_pk_bf16_f32 v22, v48, v50
    v_cvt_pk_bf16_f32 v23, v49, v51
    v_cvt_pk_bf16_f32 v38, v52, v54
    v_cvt_pk_bf16_f32 v39, v53, v55
    v_pk_add_f32 v[48:49], v[200:201], v[248:249]
    v_pk_add_f32 v[50:51], v[216:217], v[232:233] neg_lo:[0,1] neg_hi:[0,1]
    v_pk_add_f32 v[52:53], v[200:201], v[248:249] neg_lo:[0,1] neg_hi:[0,1]
    v_pk_add_f32 v[54:55], v[216:217], v[232:233] neg_lo:[1,1] neg_hi:[1,1]
    v_cvt_pk_bf16_f32 v24, v48, v50
    v_cvt_pk_bf16_f32 v25, v49, v51
    v_cvt_pk_bf16_f32 v40, v52, v54
    v_cvt_pk_bf16_f32 v41, v53, v55
    v_pk_add_f32 v[48:49], v[202:203], v[250:251]
    v_pk_add_f32 v[50:51], v[218:219], v[234:235] neg_lo:[0,1] neg_hi:[0,1]
    v_pk_add_f32 v[52:53], v[202:203], v[250:251] neg_lo:[0,1] neg_hi:[0,1]
    v_pk_add_f32 v[54:55], v[218:219], v[234:235] neg_lo:[1,1] neg_hi:[1,1]
    v_cvt_pk_bf16_f32 v26, v48, v50
    v_cvt_pk_bf16_f32 v27, v49, v51
    v_cvt_pk_bf16_f32 v42, v52, v54
    v_cvt_pk_bf16_f32 v43, v53, v55
    v_pk_add_f32 v[48:49], v[204:205], v[252:253]
    v_pk_add_f32 v[50:51], v[220:221], v[236:237] neg_lo:[0,1] neg_hi:[0,1]
    v_pk_add_f32 v[52:53], v[204:205], v[252:253] neg_lo:[0,1] neg_hi:[0,1]
    v_pk_add_f32 v[54:55], v[220:221], v[236:237] neg_lo:[1,1] neg_hi:[1,1]
    v_cvt_pk_bf16_f32 v28, v48, v50
    v_cvt_pk_bf16_f32 v29, v49, v51
    v_cvt_pk_bf16_f32 v44, v52, v54
    v_cvt_pk_bf16_f32 v45, v53, v55
    v_pk_add_f32 v[48:49], v[206:207], v[254:255]
    v_pk_add_f32 v[50:51], v[222:223], v[238:239] neg_lo:[0,1] neg_hi:[0,1]
    v_pk_add_f32 v[52:53], v[206:207], v[254:255] neg_lo:[0,1] neg_hi:[0,1]
    v_pk_add_f32 v[54:55], v[222:223], v[238:239] neg_lo:[1,1] neg_hi:[1,1]
    v_cvt_pk_bf16_f32 v30, v48, v50
    v_cvt_pk_bf16_f32 v31, v49, v51
    v_cvt_pk_bf16_f32 v46, v52, v54
    v_cvt_pk_bf16_f32 v47, v53, v55
    v_and_b32 v16, v16, v11
    v_and_b32 v17, v17, v11
    v_and_b32 v18, v18, v11
    v_and_b32 v19, v19, v11
    v_and_b32 v20, v20, v11
    v_and_b32 v21, v21, v11
    v_and_b32 v22, v22, v11
    v_and_b32 v23, v23, v11
    v_and_b32 v24, v24, v11
    v_and_b32 v25, v25, v11
    v_and_b32 v26, v26, v11
    v_and_b32 v27, v27, v11
    v_and_b32 v28, v28, v11
    v_and_b32 v29, v29, v11
    v_and_b32 v30, v30, v11
    v_and_b32 v31, v31, v11
    s_mov_b64 vcc, s[44:45]
    s_nop 0
    v_cndmask_b32_dpp v128, v17, v16, vcc quad_perm:[1,0,3,2] row_mask:0xf bank_mask:0xf
    v_cndmask_b32_dpp v130, v19, v18, vcc quad_perm:[1,0,3,2] row_mask:0xf bank_mask:0xf
    v_cndmask_b32_dpp v132, v21, v20, vcc quad_perm:[1,0,3,2] row_mask:0xf bank_mask:0xf
    v_cndmask_b32_dpp v134, v23, v22, vcc quad_perm:[1,0,3,2] row_mask:0xf bank_mask:0xf
    v_cndmask_b32_dpp v136, v25, v24, vcc quad_perm:[1,0,3,2] row_mask:0xf bank_mask:0xf
    v_cndmask_b32_dpp v138, v27, v26, vcc quad_perm:[1,0,3,2] row_mask:0xf bank_mask:0xf
    v_cndmask_b32_dpp v140, v29, v28, vcc quad_perm:[1,0,3,2] row_mask:0xf bank_mask:0xf
    v_cndmask_b32_dpp v142, v31, v30, vcc quad_perm:[1,0,3,2] row_mask:0xf bank_mask:0xf
    v_cndmask_b32_dpp v144, v33, v32, vcc quad_perm:[1,0,3,2] row_mask:0xf bank_mask:0xf
    v_cndmask_b32_dpp v146, v35, v34, vcc quad_perm:[1,0,3,2] row_mask:0xf bank_mask:0xf
    v_cndmask_b32_dpp v148, v37, v36, vcc quad_perm:[1,0,3,2] row_mask:0xf bank_mask:0xf
    v_cndmask_b32_dpp v150, v39, v38, vcc quad_perm:[1,0,3,2] row_mask:0xf bank_mask:0xf
    v_cndmask_b32_dpp v152, v41, v40, vcc quad_perm:[1,0,3,2] row_mask:0xf bank_mask:0xf
    v_cndmask_b32_dpp v154, v43, v42, vcc quad_perm:[1,0,3,2] row_mask:0xf bank_mask:0xf
    v_cndmask_b32_dpp v156, v45, v44, vcc quad_perm:[1,0,3,2] row_mask:0xf bank_mask:0xf
    v_cndmask_b32_dpp v158, v47, v46, vcc quad_perm:[1,0,3,2] row_mask:0xf bank_mask:0xf
    s_not_b64 vcc, vcc
    v_cndmask_b32_dpp v129, v16, v17, vcc quad_perm:[1,0,3,2] row_mask:0xf bank_mask:0xf
    v_cndmask_b32_dpp v131, v18, v19, vcc quad_perm:[1,0,3,2] row_mask:0xf bank_mask:0xf
    v_cndmask_b32_dpp v133, v20, v21, vcc quad_perm:[1,0,3,2] row_mask:0xf bank_mask:0xf
    v_cndmask_b32_dpp v135, v22, v23, vcc quad_perm:[1,0,3,2] row_mask:0xf bank_mask:0xf
    v_cndmask_b32_dpp v137, v24, v25, vcc quad_perm:[1,0,3,2] row_mask:0xf bank_mask:0xf
    v_cndmask_b32_dpp v139, v26, v27, vcc quad_perm:[1,0,3,2] row_mask:0xf bank_mask:0xf
    v_cndmask_b32_dpp v141, v28, v29, vcc quad_perm:[1,0,3,2] row_mask:0xf bank_mask:0xf
    v_cndmask_b32_dpp v143, v30, v31, vcc quad_perm:[1,0,3,2] row_mask:0xf bank_mask:0xf
    v_cndmask_b32_dpp v145, v32, v33, vcc quad_perm:[1,0,3,2] row_mask:0xf bank_mask:0xf
    v_cndmask_b32_dpp v147, v34, v35, vcc quad_perm:[1,0,3,2] row_mask:0xf bank_mask:0xf
    v_cndmask_b32_dpp v149, v36, v37, vcc quad_perm:[1,0,3,2] row_mask:0xf bank_mask:0xf
    v_cndmask_b32_dpp v151, v38, v39, vcc quad_perm:[1,0,3,2] row_mask:0xf bank_mask:0xf
    v_cndmask_b32_dpp v153, v40, v41, vcc quad_perm:[1,0,3,2] row_mask:0xf bank_mask:0xf
    v_cndmask_b32_dpp v155, v42, v43, vcc quad_perm:[1,0,3,2] row_mask:0xf bank_mask:0xf
    v_cndmask_b32_dpp v157, v44, v45, vcc quad_perm:[1,0,3,2] row_mask:0xf bank_mask:0xf
    v_cndmask_b32_dpp v159, v46, v47, vcc quad_perm:[1,0,3,2] row_mask:0xf bank_mask:0xf
    s_mov_b64 vcc, s[46:47]
    v_cndmask_b32_dpp v16, v130, v128, vcc quad_perm:[2,3,0,1] row_mask:0xf bank_mask:0xf
    v_cndmask_b32_dpp v17, v131, v129, vcc quad_perm:[2,3,0,1] row_mask:0xf bank_mask:0xf
    v_cndmask_b32_dpp v20, v134, v132, vcc quad_perm:[2,3,0,1] row_mask:0xf bank_mask:0xf
    v_cndmask_b32_dpp v21, v135, v133, vcc quad_perm:[2,3,0,1] row_mask:0xf bank_mask:0xf
    v_cndmask_b32_dpp v24, v138, v136, vcc quad_perm:[2,3,0,1] row_mask:0xf bank_mask:0xf
    v_cndmask_b32_dpp v25, v139, v137, vcc quad_perm:[2,3,0,1] row_mask:0xf bank_mask:0xf
    v_cndmask_b32_dpp v28, v142, v140, vcc quad_perm:[2,3,0,1] row_mask:0xf bank_mask:0xf
    v_cndmask_b32_dpp v29, v143, v141, vcc quad_perm:[2,3,0,1] row_mask:0xf bank_mask:0xf
    v_cndmask_b32_dpp v32, v146, v144, vcc quad_perm:[2,3,0,1] row_mask:0xf bank_mask:0xf
    v_cndmask_b32_dpp v33, v147, v145, vcc quad_perm:[2,3,0,1] row_mask:0xf bank_mask:0xf
    v_cndmask_b32_dpp v36, v150, v148, vcc quad_perm:[2,3,0,1] row_mask:0xf bank_mask:0xf
    v_cndmask_b32_dpp v37, v151, v149, vcc quad_perm:[2,3,0,1] row_mask:0xf bank_mask:0xf
    v_cndmask_b32_dpp v40, v154, v152, vcc quad_perm:[2,3,0,1] row_mask:0xf bank_mask:0xf
    v_cndmask_b32_dpp v41, v155, v153, vcc quad_perm:[2,3,0,1] row_mask:0xf bank_mask:0xf
    v_cndmask_b32_dpp v44, v158, v156, vcc quad_perm:[2,3,0,1] row_mask:0xf bank_mask:0xf
    v_cndmask_b32_dpp v45, v159, v157, vcc quad_perm:[2,3,0,1] row_mask:0xf bank_mask:0xf
    s_not_b64 vcc, vcc
    v_cndmask_b32_dpp v18, v128, v130, vcc quad_perm:[2,3,0,1] row_mask:0xf bank_mask:0xf
    v_cndmask_b32_dpp v19, v129, v131, vcc quad_perm:[2,3,0,1] row_mask:0xf bank_mask:0xf
    v_cndmask_b32_dpp v22, v132, v134, vcc quad_perm:[2,3,0,1] row_mask:0xf bank_mask:0xf
    v_cndmask_b32_dpp v23, v133, v135, vcc quad_perm:[2,3,0,1] row_mask:0xf bank_mask:0xf
    v_cndmask_b32_dpp v26, v136, v138, vcc quad_perm:[2,3,0,1] row_mask:0xf bank_mask:0xf
    v_cndmask_b32_dpp v27, v137, v139, vcc quad_perm:[2,3,0,1] row_mask:0xf bank_mask:0xf
    v_cndmask_b32_dpp v30, v140, v142, vcc quad_perm:[2,3,0,1] row_mask:0xf bank_mask:0xf
    v_cndmask_b32_dpp v31, v141, v143, vcc quad_perm:[2,3,0,1] row_mask:0xf bank_mask:0xf
    v_cndmask_b32_dpp v34, v144, v146, vcc quad_perm:[2,3,0,1] row_mask:0xf bank_mask:0xf
    v_cndmask_b32_dpp v35, v145, v147, vcc quad_perm:[2,3,0,1] row_mask:0xf bank_mask:0xf
    v_cndmask_b32_dpp v38, v148, v150, vcc quad_perm:[2,3,0,1] row_mask:0xf bank_mask:0xf
    v_cndmask_b32_dpp v39, v149, v151, vcc quad_perm:[2,3,0,1] row_mask:0xf bank_mask:0xf
    v_cndmask_b32_dpp v42, v152, v154, vcc quad_perm:[2,3,0,1] row_mask:0xf bank_mask:0xf
    v_cndmask_b32_dpp v43, v153, v155, vcc quad_perm:[2,3,0,1] row_mask:0xf bank_mask:0xf
    v_cndmask_b32_dpp v46, v156, v158, vcc quad_perm:[2,3,0,1] row_mask:0xf bank_mask:0xf
    v_cndmask_b32_dpp v47, v157, v159, vcc quad_perm:[2,3,0,1] row_mask:0xf bank_mask:0xf
    s_add_u32 s39, s38, 0
    buffer_store_dwordx4 v[16:19], v12, s[32:35], s39 offen sc1
    buffer_store_dwordx4 v[32:35], v12, s[32:35], s39 offen offset:1024 sc1
    s_add_u32 s39, s38, 16384
    buffer_store_dwordx4 v[20:23], v12, s[32:35], s39 offen sc1
    buffer_store_dwordx4 v[36:39], v12, s[32:35], s39 offen offset:1024 sc1
    s_add_u32 s39, s38, 32768
    buffer_store_dwordx4 v[24:27], v12, s[32:35], s39 offen sc1
    buffer_store_dwordx4 v[40:43], v12, s[32:35], s39 offen offset:1024 sc1
    s_add_u32 s39, s38, 49152
    buffer_store_dwordx4 v[28:31], v12, s[32:35], s39 offen sc1
    buffer_store_dwordx4 v[44:47], v12, s[32:35], s39 offen offset:1024 sc1
    v_mov_b32 v48, 162816
    v_mov_b32 v49, 1
    s_lshl_b32 s53, s22, 2
    s_add_u32 s53, s53, s23
    s_lshl_b32 s53, s53, 7
    s_add_u32 s53, s53, 9469952
    s_mov_b64 exec, 1
    s_waitcnt vmcnt(0)
    ds_add_rtn_u32 v18, v48, v49
    v_mov_b32 v20, s92
    v_mov_b32 v21, s93
    v_mov_b32 v22, 0
    s_waitcnt lgkmcnt(0)
    v_readfirstlane_b32 s54, v18
    s_nop 3
    s_cmp_eq_u32 s54, 3
    s_cselect_b32 s53, s53, 2130706432
    buffer_store_dwordx2 v[20:21], v22, s[32:35], s53 offen sc1
    s_mov_b64 exec, -1
    s_branch L_FIN
L_END:
    s_endpgm
.p2align 8
.type L_CSTAB,@object
L_CSTAB:
.long 0x00000000, 0xb308c000, 0x349de800, 0xb2cd8000, 0x357e5400, 0xb4950000, 0xb6039b00, 0xb5b30000
.long 0x34b4a800, 0x36049800, 0x361b2000, 0xb5420000, 0xb6079b00, 0x35b78000, 0xb6328000, 0xbb801100
.long 0x37317540, 0xbb7fb300, 0xbb7f9dda, 0xbb800be8, 0x3b803eb8, 0xbb7fbd80, 0xbb7ff848, 0xb6368000
.long 0x375c9940, 0x36b16000, 0x3b805724, 0xbc0000f0, 0x3b801374, 0xbb7f9140, 0xbb803200, 0x3bfff340
.long 0x38226f50, 0xbb801dd0, 0xbb7ec640, 0xbb8037a0, 0x36c90c00, 0x36b4c000, 0xbb8017e8, 0xb4a80000
.long 0x37957800, 0xb57d0000, 0xbb7f7a80, 0xb71b7000, 0xbbffe814, 0x368c0000, 0x3c001914, 0xbbfff880
.long 0x37599940, 0x3b804e00, 0x3b807898, 0xb68d0000, 0x3b806e44, 0x3b8038d0, 0xbc0031b0, 0xbb001cb0
.long 0x374bd600, 0xbb801c30, 0x3b80ae20, 0x370d4000, 0x3b808c00, 0x378ec000, 0x3bff6620, 0xb7480000
.long 0x384d41d0, 0xbafe1950, 0xbb7ef6a0, 0xb71de000, 0x3789e000, 0x3b8024c0, 0xb75f4000, 0x353c0000
.long 0x37b4b300, 0xb6c1c000, 0xbb7e0b4c, 0x37360000, 0x3b7d9eb0, 0xbb7e8a78, 0xbb806520, 0xbb809008
.long 0x3703e400, 0xbbff9ac0, 0x37eff800, 0xb6ec8000, 0xbc003ce0, 0x3720c000, 0x3693a000, 0xbaff9700
.long 0x381fb600, 0x3b7ff688, 0x370c0000, 0xbb012100, 0x3c206274, 0x3b014bc0, 0xbc3fd890, 0xbb007800
.long 0x38da9128, 0xbb7f5e00, 0xbb806440, 0xbbc066b0, 0x3b0223b0, 0xbb000800, 0xbb000d40, 0xbc1f08c0
.long 0x379cd400, 0xbc002c80, 0xbb009c60, 0xbb82bcc0, 0xbc4013b0, 0xbb802e00, 0x3aff8ca0, 0xbb806740
.long 0x38066580, 0x383ec800, 0xbc203c78, 0x3bc1ed80, 0x3b819b60, 0xbafb5f80, 0xbbbff2b0, 0xbb7f7ac0
.long 0x38038000, 0x37d2c000, 0x373a8000, 0xbaffa080, 0xbbbeb360, 0xbafe0700, 0x3afce000, 0x3b806d10
.long 0x38926be8, 0x388a2000, 0x37675800, 0x3bbec100, 0x37c93000, 0x3bbfd340, 0xbaff77c0, 0x380b4000
.long 0x38d8bc00, 0x3c00ff3c, 0x3b804940, 0x3b02d800, 0xbb80df60, 0xbbc056c0, 0xbb0167c0, 0xb6fa0000
.long 0x37b9b300, 0x3b8153c0, 0x3b7e3f20, 0xb874c000, 0xbbbd6be6, 0xbbff01c0, 0x3b00ec00, 0xbb7c2980
.long 0xb73e4000, 0x3b015400, 0xbbbeca7c, 0xbb037f40, 0x3c1f6ae4, 0x3b04ab00, 0xbbc1a008, 0x3afa5500
.long 0xb8312f00, 0xbb7f0012, 0xbbbff5c0, 0x3c213560, 0x38b7de00, 0xbb7faa00, 0xbb807620, 0x3c00a000
.long 0x35c20000, 0xbb015430, 0xbafb7dc0, 0xb8bad400, 0xbafbd660, 0x3bfd80c0, 0xbbff4bc0, 0xb6380000
.long 0x38e38b00, 0x3b85ac00, 0xb59bc000, 0x3af6fb00, 0x3b011900, 0x3b05ad00, 0xbbc52180, 0xbaf5b100
.long 0x38750380, 0x3b81012a, 0x3bd1cc60, 0xb84ba000, 0xbbc32120, 0x3bfe2d00, 0xbbbff600, 0x3ae8f400
.long 0x38d75e28, 0xbc1fd460, 0xbc42af00, 0xb7ed8000, 0xbc00e3e0, 0xbae1f600, 0xbc00a718, 0x3a8ba000
.long 0x3891ba00, 0x3adeb660, 0xbb868800, 0x3a6de800, 0x3c611910, 0xbae8a080, 0xbbfc2380, 0xbbc26e00
.long 0x37f8fc00, 0xbae3f800, 0xbca06c80, 0x3b846700, 0xbbc15db0, 0x3b025dc0, 0xbb03f340, 0x3c031e40
.long 0x37294000, 0xbb0b4e00, 0xbc032d80, 0x39811700, 0x3aff18a0, 0xbb0af800, 0x3b1e6180, 0x3afb9c00
.long 0xb9fa4350, 0x3c015840, 0x3c403d48, 0x3b7d7680, 0xbbbf31b0, 0xbbee2600, 0x3bc25b60, 0xbbc27000
.long 0x38df2800, 0x3b800590, 0x3c01a7d0, 0xbb093600, 0x3bbf9a90, 0x3bbf2fc0, 0xbc203d30, 0xb918ac00
.long 0xb4a00000, 0x3b0eb580, 0x3bf42540, 0xbb9df000, 0xbbfc0500, 0xb9b7a000, 0x3b902fe0, 0x38726800
.long 0x39233500, 0x3a157c00, 0xbb8103c0, 0xbafd1c00, 0xbc61c8c0, 0x3b82da40, 0x3c61ad88, 0xbbf77100
.long 0x00000000, 0x33bc0000, 0xb388c000, 0x32cd0000, 0x35ce8c00, 0x35350000, 0x334d8000, 0x35b20000
.long 0x357eb800, 0x339a0000, 0xb5150000, 0x36310000, 0x36839700, 0x35b90000, 0x36330000, 0x34000000
.long 0xb688e100, 0x3b801680, 0x3b802126, 0xbb7fe820, 0x3b8026c8, 0x3b802180, 0xbb7fe7c0, 0xb5920000
.long 0x3742c780, 0x3c000628, 0x3b8016f0, 0x3b8021c0, 0x36b28000, 0xb58c0000, 0x3b802200, 0xbbfff340
.long 0x3788dbc0, 0xbbffddc0, 0x3b804d00, 0xbb7f9080, 0x37447c00, 0x35d20000, 0xbb7fd060, 0x368a0000
.long 0xb4a80000, 0xb57e0000, 0x3c002140, 0x3b800d90, 0xbc00440c, 0x368c0000, 0x36b68000, 0x3b803880
.long 0x37e2dfc0, 0x3c002700, 0x3c002c58, 0x37470000, 0x36b96000, 0x3b7ff1c0, 0x3c0001e0, 0xbbfff1b0
.long 0xb69da000, 0x3c0011e0, 0x375d8000, 0xbc1fe360, 0xbb7e3800, 0x371d0000, 0xbbffe680, 0x3c003200
.long 0xb8503220, 0xbb800658, 0xbc401dd0, 0xbb7fe1c0, 0x3b7f7280, 0x3b802480, 0xbb7f2180, 0x36e80000
.long 0xb79ab200, 0xbafec200, 0xbc1fd2d0, 0x3b806500, 0x3c009848, 0xb5310000, 0x3c0002a0, 0x3b001fe0
.long 0x37aab000, 0x36960000, 0xb5fd0000, 0x3bc03ac0, 0x3b808580, 0x3b03a080, 0x3b809b70, 0x3b806600
.long 0xb7b08800, 0xb5170000, 0x3b008c00, 0x3b809100, 0xbafd9338, 0x3af89900, 0x3bfff100, 0x3c005e00
.long 0xb6554200, 0xbb7f5e00, 0x3c204e00, 0xbc1f0cb0, 0x3c207878, 0xbc3fc200, 0xbafee600, 0x3c0008c0
.long 0x382e2400, 0x3c205380, 0x3bc071a0, 0x36f20000, 0xbb7e7280, 0xbb7c5c00, 0xbb7fc6a0, 0xbc5fcc40
.long 0x36bee800, 0xbc000190, 0x3b7f8f40, 0x3c404900, 0x3b815c40, 0xb86c2000, 0xbc6046a0, 0x37bd0000
.long 0xb7980000, 0xbb81ad80, 0xbafb8a00, 0x38742000, 0x3819e000, 0xbbbf8280, 0x3b80c800, 0xb8767000
.long 0x36018e00, 0x3b015200, 0xbafc32a0, 0xbbffc200, 0xbc5f7b70, 0xbafcb000, 0x3b809de0, 0xbc3fcb80
.long 0xb836a000, 0xbc3f00c4, 0x3b804980, 0x38a50000, 0x37de4000, 0x3bfe2980, 0xbb001780, 0xbc00a080
.long 0xb7963200, 0xbaf6ae00, 0xbc403070, 0xbafc5800, 0xbc7f85ba, 0xbb7b0100, 0xb7b60000, 0xbb7bd680
.long 0xb79f7000, 0x3bc0aa00, 0xbb7d14f0, 0xbb81c040, 0xbaf8d500, 0x3b82d500, 0x38100800, 0x3c003540
.long 0xb87cf200, 0xbaffffb8, 0x3b80ca80, 0x3b032b00, 0x386fd800, 0xbb7faa00, 0x3b807640, 0xbafd0000
.long 0xb7f58000, 0xbbfcaa00, 0xbbc35f40, 0x3bfbeb60, 0xbb009420, 0x3bc28100, 0xb6d20000, 0x3bc11600
.long 0xb7ffe800, 0xbc012a00, 0x3affda20, 0x3b088300, 0x3afa3000, 0xbafca400, 0x3b024200, 0xbbce9400
.long 0x383c4700, 0xbb7bfca8, 0x3bbd4bc0, 0xbc3eb480, 0x3bff6140, 0x3b8b2c00, 0x3c403c00, 0x3af70800
.long 0xb9023908, 0xbb7f5100, 0x39144000, 0xbb062600, 0xb7c88000, 0x3afe0800, 0xbbc332a0, 0x3c000c00
.long 0xb86e0800, 0xbc3ca980, 0xbc400400, 0x38d08000, 0xbb03e580, 0xbc0313e0, 0x3c021180, 0x375c0000
.long 0x385d2400, 0xba83f000, 0x3bff4e00, 0x3b879800, 0x3bc16320, 0x3bc42e40, 0x3c00bcc0, 0x3b058800
.long 0x38943000, 0xbc015300, 0xbb845c00, 0xbb7c22c0, 0xbbffc690, 0x3c204200, 0xbcabcc60, 0xbb49cc00
.long 0xba090050, 0x3a4d7800, 0xbc1e8270, 0xbb7f7700, 0x38083000, 0xbb9d2600, 0x3bc42500, 0xbb849000
.long 0x38ceb000, 0x3c1a0270, 0xbac6bf00, 0xbb22cc00, 0xbc8006b8, 0x3a8cc000, 0xbb808540, 0xbc111d60
.long 0x37640000, 0x3b805a80, 0x3af69600, 0xbaf44000, 0xbb028700, 0xba33d000, 0xbbc02fc0, 0x3bfa1b20
.long 0xb79bc000, 0xbb769e00, 0xbbbf0380, 0x3c02a300, 0xbb826e00, 0xbbe02480, 0xb91b4400, 0xbbbd8f00
.size L_CSTAB, 2048

.section .rodata,"a"
.p2align 6
.amdhsa_kernel recurrent_scan__spectral_fnet__geglu_ffn__prompt_kernel
  .amdhsa_next_free_vgpr 256
  .amdhsa_next_free_sgpr 102
  .amdhsa_accum_offset 256
  .amdhsa_group_segment_fixed_size 0
  .amdhsa_kernarg_size 96
  .amdhsa_user_sgpr_count 2
  .amdhsa_user_sgpr_kernarg_segment_ptr 1
  .amdhsa_system_sgpr_workgroup_id_x 1
.end_amdhsa_kernel
```
